```python
import torch

def _softmax(x, axis=-1):
    return torch.softmax(x, dim=axis)
def _gelu(x):
    return torch.nn.functional.gelu(x, approximate="tanh")
def _silu(x):
    return torch.nn.functional.silu(x)
def _sigmoid(x):
    return torch.sigmoid(x)
def _layernorm(x, axis=-1, eps=1e-5):
    m = x.mean(dim=axis, keepdim=True)
    v = x.var(dim=axis, keepdim=True, unbiased=False)
    return (x - m) / torch.sqrt(v + eps)
def _scatter_add(tgt, idx, src, axis=0):
    return tgt.clone().index_add_(axis, idx, src)
def _segment_sum(src, seg, n):
    out = torch.zeros((n,) + src.shape[1:], dtype=src.dtype)
    return out.index_add_(0, seg, src)
def _pad(x, pw):
    flat = tuple(v for pair in reversed(pw) for v in pair)
    return torch.nn.functional.pad(x, flat)

kernel_name = 'parallel_sum__mha_block_cached__glu_gated_glu__decode'

def setup_inputs():

    _w = (lambda a: (lambda t: t.to(torch.bfloat16) if t.is_floating_point() else t)(torch.as_tensor(a)))
    def _A_setup():
        B, Sq, D = 1, 1, 640
        H, Sk, Dh = 32, 4096, 192
        return {
            "x": _w((lambda *s: torch.randn(*s, dtype=torch.bfloat16) * 0.05)(B, Sq, D)),
            "k_cache": _w((lambda *s: torch.randn(*s, dtype=torch.bfloat16) * 3.2)(B, H, Sk, Dh)),
            "v_cache": _w((lambda *s: torch.randn(*s, dtype=torch.bfloat16) * 1.6)(B, H, Sk, Dh)),
            "wq": _w((lambda *s: torch.randn(*s, dtype=torch.bfloat16) * 3.2)(D, H * Dh) * (D ** -0.5)),
            "wo": _w((lambda *s: torch.randn(*s, dtype=torch.bfloat16) * 1.6)(H * Dh, D) * ((H * Dh) ** -0.5)),
        }
    _A_in = _A_setup()

    def _B_setup():
        B, S, D, F = 1, 1, 640, 1536
        return {
            "x": _w((lambda *s: torch.randn(*s, dtype=torch.bfloat16) * 0.05)(B, S, D)),
            "w_gate": _w((lambda *s: torch.randn(*s, dtype=torch.bfloat16) * 1.6)(D, F)),
            "w_up": _w((lambda *s: torch.randn(*s, dtype=torch.bfloat16) * 0.1)(D, F)),
            "w_down": _w((lambda *s: torch.randn(*s, dtype=torch.bfloat16) * 0.1)(F, D)),
        }
    _B_in = _B_setup()

    return {
        "A_x": _A_in["x"],
        "A_k_cache": _A_in["k_cache"],
        "A_v_cache": _A_in["v_cache"],
        "A_wq": _A_in["wq"],
        "A_wo": _A_in["wo"],
        "B_x": _B_in["x"],
        "B_w_gate": _B_in["w_gate"],
        "B_w_up": _B_in["w_up"],
        "B_w_down": _B_in["w_down"],
    }

def reference(A_x, A_k_cache, A_v_cache, A_wq, A_wo, B_x, B_w_gate, B_w_up, B_w_down):
    def _A_ref(x, k_cache, v_cache, wq, wo):
        B, Sq, D = x.shape
        H, Dh = 32, 192
        q = (lambda x, *d: x.permute(*d))((x @ wq).reshape(B, Sq, H, Dh), 0, 2, 1, 3)
        scores = torch.einsum("bhqd,bhkd->bhqk", q, k_cache) * (Dh ** -0.5)
        p = _softmax(scores, axis=-1)
        o = torch.einsum("bhqk,bhkd->bhqd", p, v_cache)
        return (lambda x, *d: x.permute(*d))(o, 0, 2, 1, 3).reshape(B, Sq, H * Dh) @ wo

    def _B_ref(x, w_gate, w_up, w_down):
        g = torch.einsum("bsd,df->bsf", x, w_gate)
        u = torch.einsum("bsd,df->bsf", x, w_up)
        h = _sigmoid(g) * u
        return torch.einsum("bsf,fd->bsd", h, w_down)

    x = A_x
    xn = _layernorm(x, axis=-1)
    return x + _A_ref(xn, A_k_cache, A_v_cache, A_wq, A_wo) + _B_ref(xn, B_w_gate, B_w_up, B_w_down)
```

```asm
; @launch grid=(256,1,1) block=(768,1,1) lds=19968
.amdgcn_target "amdgcn-amd-amdhsa--gfx950"
.text
.globl parallel_sum__mha_block_cached__glu_gated_glu__decode_kernel
.p2align 8
.type parallel_sum__mha_block_cached__glu_gated_glu__decode_kernel,@function
parallel_sum__mha_block_cached__glu_gated_glu__decode_kernel:
L_start:
    s_cmp_ge_u32 s2, 256
    s_cbranch_scc1 L_end
    s_load_dwordx2 s[48:49], s[0:1], 88
    v_lshrrev_b32 v1, 6, v0
    s_bfe_u32 s5, s2, 0x30003
    v_readfirstlane_b32 s3, v1
    s_and_b32 s60, s2, 7
    s_lshr_b32 s61, s2, 6
    s_lshl_b32 s4, s60, 2
    s_add_u32 s4, s4, s61
    s_mov_b32 s50, 268435456
    s_mov_b32 s51, 0x20000
    s_sub_u32 s7, s3, 4
    s_cbranch_scc1 L_help
    s_memrealtime s[62:63]
    s_load_dwordx2 s[12:13], s[0:1], 8
    s_mov_b32 s14, 50331648
    s_mov_b32 s15, 0x20000
    v_and_b32 v0, 63, v0
    v_lshrrev_b32 v1, 3, v0
    v_and_b32 v2, 7, v0
    v_mov_b32 v29, 0
    v_lshlrev_b32 v28, 2, v0
    ds_write_b32 v28, v29 offset:512
    s_lshl_b32 s6, s4, 3
    s_add_u32 s6, s6, s5
    v_mul_u32_u24 v3, 384, v1
    v_lshl_add_u32 v3, v2, 4, v3
    s_lshl_b32 s52, s6, 3
    s_add_u32 s52, s52, s7
    s_mul_i32 s52, s52, 24576
    s_setprio 2
    s_waitcnt lgkmcnt(0)
    s_lshr_b32 s53, s2, 6
    s_or_b32 s53, s53, s7
    s_cbranch_scc1 L_nsp
    s_add_u32 s53, s2, 64
    s_lshl_b32 s53, s53, 7
    v_mov_b32 v30, s62
    s_mov_b64 exec, 1
    buffer_store_dword v30, v29, s[48:51], s53 offen sc1
    s_cmp_lg_u32 s2, 0
    s_cbranch_scc1 L_nsp0
    s_mov_b64 exec, 0xffff
    v_lshlrev_b32 v31, 7, v0
    s_mov_b32 s53, 16384
    buffer_store_dword v29, v31, s[48:51], s53 offen sc1
L_nsp0:
    s_mov_b64 exec, -1
L_nsp:
    s_barrier
    s_branch L_stream
L_help:
    s_setprio 3
    s_memrealtime s[46:47]
    s_load_dwordx2 s[8:9], s[0:1], 0
    s_mov_b32 s10, 1280
    s_mov_b32 s11, 0x20000
    v_and_b32 v0, 63, v0
    v_lshrrev_b32 v1, 3, v0
    v_and_b32 v2, 7, v0
    s_mov_b32 s7, s3
    v_mul_u32_u24 v4, 20, v0
    v_mul_u32_u24 v5, 20, v1
    s_cmp_ge_u32 s5, 6
    s_cbranch_scc1 L_hB
    s_load_dwordx2 s[20:21], s[0:1], 24
    s_mov_b32 s22, 7864320
    s_mov_b32 s23, 0x20000
    s_and_b32 s52, s5, 1
    s_mul_i32 s52, s52, 320
    s_mul_i32 s53, s7, 80
    s_add_u32 s55, s52, s53
    v_mul_u32_u24 v3, 122880, v1
    v_lshl_add_u32 v3, v2, 4, v3
    s_mul_i32 s52, s55, 12288
    s_mul_i32 s53, s4, 384
    s_add_u32 s52, s52, s53
    s_lshr_b32 s53, s5, 1
    s_lshl_b32 s53, s53, 7
    s_add_u32 s52, s52, s53
    s_lshl_b32 s55, s55, 1
    s_waitcnt lgkmcnt(0)
    buffer_load_dwordx4 v[8:11], v4, s[8:11], 0 offen
    buffer_load_dword v12, v4, s[8:11], 0 offen offset:16
    buffer_load_dwordx4 v[14:17], v5, s[8:11], s55 offen
    buffer_load_dword v18, v5, s[8:11], s55 offen offset:16
    buffer_load_dwordx4 v[64:67], v3, s[20:23], s52 offen nt
    s_add_u32 s52, s52, 12288
    buffer_load_dwordx4 v[68:71], v3, s[20:23], s52 offen nt
    s_add_u32 s52, s52, 12288
    buffer_load_dwordx4 v[72:75], v3, s[20:23], s52 offen nt
    s_add_u32 s52, s52, 12288
    buffer_load_dwordx4 v[76:79], v3, s[20:23], s52 offen nt
    s_add_u32 s52, s52, 12288
    buffer_load_dwordx4 v[80:83], v3, s[20:23], s52 offen nt
    s_add_u32 s52, s52, 12288
    buffer_load_dwordx4 v[84:87], v3, s[20:23], s52 offen nt
    s_add_u32 s52, s52, 12288
    buffer_load_dwordx4 v[88:91], v3, s[20:23], s52 offen nt
    s_add_u32 s52, s52, 12288
    buffer_load_dwordx4 v[92:95], v3, s[20:23], s52 offen nt
    s_add_u32 s52, s52, 12288
    buffer_load_dwordx4 v[96:99], v3, s[20:23], s52 offen nt
    s_add_u32 s52, s52, 12288
    buffer_load_dwordx4 v[100:103], v3, s[20:23], s52 offen nt
    s_branch L_hinit
L_hB:
    s_bitcmp1_b32 s5, 0
    s_cbranch_scc1 L_hBu
    s_load_dwordx2 s[20:21], s[0:1], 48
    s_branch L_hB2
L_hBu:
    s_load_dwordx2 s[20:21], s[0:1], 56
L_hB2:
    s_mov_b32 s22, 1966080
    s_mov_b32 s23, 0x20000
    s_mul_i32 s52, s61, 160
    s_lshr_b32 s53, s7, 1
    s_mul_i32 s53, s53, 80
    s_add_u32 s55, s52, s53
    s_and_b32 s53, s7, 1
    s_mul_i32 s53, s53, 5
    s_add_u32 s52, s55, s53
    v_mul_u32_u24 v3, 30720, v1
    v_lshl_add_u32 v3, v2, 4, v3
    s_mul_i32 s52, s52, 3072
    s_mul_i32 s53, s60, 384
    s_add_u32 s52, s52, s53
    s_lshl_b32 s55, s55, 1
    s_waitcnt lgkmcnt(0)
    buffer_load_dwordx4 v[8:11], v4, s[8:11], 0 offen
    buffer_load_dword v12, v4, s[8:11], 0 offen offset:16
    buffer_load_dwordx4 v[14:17], v5, s[8:11], s55 offen
    buffer_load_dword v18, v5, s[8:11], s55 offen offset:16
    buffer_load_dwordx4 v[64:67], v3, s[20:23], s52 offen offset:0 nt
    buffer_load_dwordx4 v[68:71], v3, s[20:23], s52 offen offset:128 nt
    buffer_load_dwordx4 v[72:75], v3, s[20:23], s52 offen offset:256 nt
    s_add_u32 s52, s52, 3072
    buffer_load_dwordx4 v[76:79], v3, s[20:23], s52 offen offset:0 nt
    buffer_load_dwordx4 v[80:83], v3, s[20:23], s52 offen offset:128 nt
    buffer_load_dwordx4 v[84:87], v3, s[20:23], s52 offen offset:256 nt
    s_add_u32 s52, s52, 3072
    buffer_load_dwordx4 v[88:91], v3, s[20:23], s52 offen offset:0 nt
    buffer_load_dwordx4 v[92:95], v3, s[20:23], s52 offen offset:128 nt
    buffer_load_dwordx4 v[96:99], v3, s[20:23], s52 offen offset:256 nt
    s_add_u32 s52, s52, 3072
    buffer_load_dwordx4 v[100:103], v3, s[20:23], s52 offen offset:0 nt
    buffer_load_dwordx4 v[104:107], v3, s[20:23], s52 offen offset:128 nt
    buffer_load_dwordx4 v[108:111], v3, s[20:23], s52 offen offset:256 nt
    s_add_u32 s52, s52, 3072
    buffer_load_dwordx4 v[112:115], v3, s[20:23], s52 offen offset:0 nt
    buffer_load_dwordx4 v[116:119], v3, s[20:23], s52 offen offset:128 nt
    buffer_load_dwordx4 v[120:123], v3, s[20:23], s52 offen offset:256 nt
L_hinit:
    s_mov_b32 s69, s46
    s_barrier
    s_load_dword s64, s[48:49], 0
    s_load_dwordx2 s[24:25], s[0:1], 32
    s_mov_b32 s26, 7864320
    s_mov_b32 s27, 0x20000
    s_load_dwordx2 s[36:37], s[0:1], 64
    s_mov_b32 s38, 1966080
    s_mov_b32 s39, 0x20000
    s_load_dwordx2 s[40:41], s[0:1], 72
    s_mov_b32 s42, 1280
    s_mov_b32 s43, 0x20000
    s_lshl_b32 s6, s4, 3
    s_add_u32 s6, s6, s5
    v_and_b32 v6, 1, v2
    v_lshlrev_b32 v6, 4, v6
    v_mov_b32 v7, 0xffff
    v_lshlrev_b32 v6, v6, v7
    v_lshrrev_b32 v7, 1, v2
    v_cmp_eq_u32 vcc, 0, v7
    s_nop 1
    v_cndmask_b32 v24, 0, v6, vcc
    v_cmp_eq_u32 vcc, 1, v7
    s_nop 1
    v_cndmask_b32 v25, 0, v6, vcc
    v_cmp_eq_u32 vcc, 2, v7
    s_nop 1
    v_cndmask_b32 v26, 0, v6, vcc
    v_cmp_eq_u32 vcc, 3, v7
    s_nop 1
    v_cndmask_b32 v27, 0, v6, vcc
    v_lshrrev_b32 v20, 5, v0
    v_mul_u32_u24 v20, 256, v20
    v_lshl_add_u32 v20, v2, 5, v20
    v_and_b32 v21, 16, v0
    v_add_u32 v20, v20, v21
    s_mul_i32 s57, s7, 512
    v_add_u32 v20, s57, v20
    v_lshlrev_b32 v21, 2, v0
    v_lshlrev_b32 v22, 3, v0
    s_lshl_b32 s58, s7, 2
    v_mov_b32 v19, s58
    v_and_b32 v23, 12, v21
    v_mov_b32 v7, 1
    s_waitcnt vmcnt(15)
    s_cmp_ge_u32 s5, 6
    s_cbranch_scc1 L_hx
    s_waitcnt vmcnt(10)
L_hx:
    v_lshlrev_b32 v28, 16, v8
    v_and_b32 v29, 0xffff0000, v8
    v_lshlrev_b32 v30, 16, v9
    v_and_b32 v31, 0xffff0000, v9
    v_lshlrev_b32 v32, 16, v10
    v_and_b32 v33, 0xffff0000, v10
    v_lshlrev_b32 v34, 16, v11
    v_and_b32 v35, 0xffff0000, v11
    v_lshlrev_b32 v36, 16, v12
    v_and_b32 v37, 0xffff0000, v12
    v_add_f32 v38, v28, v29
    v_add_f32 v38, v38, v30
    v_add_f32 v38, v38, v31
    v_add_f32 v38, v38, v32
    v_add_f32 v38, v38, v33
    v_add_f32 v38, v38, v34
    v_add_f32 v38, v38, v35
    v_add_f32 v38, v38, v36
    v_add_f32 v38, v38, v37
    s_nop 1
    v_add_f32_dpp v38, v38, v38 quad_perm:[1,0,3,2] row_mask:0xf bank_mask:0xf
    s_nop 1
    v_add_f32_dpp v38, v38, v38 quad_perm:[2,3,0,1] row_mask:0xf bank_mask:0xf
    s_nop 1
    v_add_f32_dpp v38, v38, v38 row_half_mirror row_mask:0xf bank_mask:0xf
    s_nop 1
    v_add_f32_dpp v38, v38, v38 row_ror:8 row_mask:0xf bank_mask:0xf
    s_nop 1
    v_add_f32_dpp v38, v38, v38 row_bcast:15 row_mask:0xa bank_mask:0xf
    s_nop 1
    v_add_f32_dpp v38, v38, v38 row_bcast:31 row_mask:0xc bank_mask:0xf
    s_nop 0
    v_readlane_b32 s56, v38, 63
    v_mov_b32 v39, 0x3acccccd
    s_nop 0
    v_mul_f32 v39, s56, v39
    v_sub_f32 v28, v28, v39
    v_sub_f32 v29, v29, v39
    v_sub_f32 v30, v30, v39
    v_sub_f32 v31, v31, v39
    v_sub_f32 v32, v32, v39
    v_sub_f32 v33, v33, v39
    v_sub_f32 v34, v34, v39
    v_sub_f32 v35, v35, v39
    v_sub_f32 v36, v36, v39
    v_sub_f32 v37, v37, v39
    v_mul_f32 v38, v28, v28
    v_fmac_f32 v38, v29, v29
    v_fmac_f32 v38, v30, v30
    v_fmac_f32 v38, v31, v31
    v_fmac_f32 v38, v32, v32
    v_fmac_f32 v38, v33, v33
    v_fmac_f32 v38, v34, v34
    v_fmac_f32 v38, v35, v35
    v_fmac_f32 v38, v36, v36
    v_fmac_f32 v38, v37, v37
    s_nop 1
    v_add_f32_dpp v38, v38, v38 quad_perm:[1,0,3,2] row_mask:0xf bank_mask:0xf
    s_nop 1
    v_add_f32_dpp v38, v38, v38 quad_perm:[2,3,0,1] row_mask:0xf bank_mask:0xf
    s_nop 1
    v_add_f32_dpp v38, v38, v38 row_half_mirror row_mask:0xf bank_mask:0xf
    s_nop 1
    v_add_f32_dpp v38, v38, v38 row_ror:8 row_mask:0xf bank_mask:0xf
    s_nop 1
    v_add_f32_dpp v38, v38, v38 row_bcast:15 row_mask:0xa bank_mask:0xf
    s_nop 1
    v_add_f32_dpp v38, v38, v38 row_bcast:31 row_mask:0xc bank_mask:0xf
    s_nop 0
    v_readlane_b32 s56, v38, 63
    v_mov_b32 v38, 0x3acccccd
    s_nop 0
    v_mul_f32 v38, s56, v38
    v_cvt_pk_bf16_f32 v38, v38, v39
    v_and_b32 v39, 0xffff0000, v38
    v_lshlrev_b32 v38, 16, v38
    v_add_f32 v38, 0x3727c5ac, v38
    v_cvt_pk_bf16_f32 v38, v38, v38
    v_lshlrev_b32 v38, 16, v38
    v_sqrt_f32 v38, v38
    s_nop 0
    v_cvt_pk_bf16_f32 v38, v38, v38
    v_lshlrev_b32 v38, 16, v38
    v_rcp_f32 v38, v38
    v_lshlrev_b32 v28, 16, v14
    v_and_b32 v29, 0xffff0000, v14
    v_lshlrev_b32 v30, 16, v15
    v_and_b32 v31, 0xffff0000, v15
    v_lshlrev_b32 v32, 16, v16
    v_and_b32 v33, 0xffff0000, v16
    v_lshlrev_b32 v34, 16, v17
    v_and_b32 v35, 0xffff0000, v17
    v_lshlrev_b32 v36, 16, v18
    v_and_b32 v37, 0xffff0000, v18
    v_sub_f32 v28, v28, v39
    v_sub_f32 v29, v29, v39
    v_sub_f32 v30, v30, v39
    v_sub_f32 v31, v31, v39
    v_sub_f32 v32, v32, v39
    v_sub_f32 v33, v33, v39
    v_sub_f32 v34, v34, v39
    v_sub_f32 v35, v35, v39
    v_sub_f32 v36, v36, v39
    v_sub_f32 v37, v37, v39
    v_cvt_pk_bf16_f32 v8, v28, v29
    v_cvt_pk_bf16_f32 v9, v30, v31
    v_cvt_pk_bf16_f32 v10, v32, v33
    v_cvt_pk_bf16_f32 v11, v34, v35
    v_cvt_pk_bf16_f32 v12, v36, v37
    v_lshlrev_b32 v28, 16, v8
    v_and_b32 v29, 0xffff0000, v8
    v_lshlrev_b32 v30, 16, v9
    v_and_b32 v31, 0xffff0000, v9
    v_lshlrev_b32 v32, 16, v10
    v_and_b32 v33, 0xffff0000, v10
    v_lshlrev_b32 v34, 16, v11
    v_and_b32 v35, 0xffff0000, v11
    v_lshlrev_b32 v36, 16, v12
    v_and_b32 v37, 0xffff0000, v12
    v_mul_f32 v28, v28, v38
    v_mul_f32 v29, v29, v38
    v_mul_f32 v30, v30, v38
    v_mul_f32 v31, v31, v38
    v_mul_f32 v32, v32, v38
    v_mul_f32 v33, v33, v38
    v_mul_f32 v34, v34, v38
    v_mul_f32 v35, v35, v38
    v_mul_f32 v36, v36, v38
    v_mul_f32 v37, v37, v38
    v_cvt_pk_bf16_f32 v28, v28, v28
    v_cvt_pk_bf16_f32 v29, v29, v29
    v_cvt_pk_bf16_f32 v30, v30, v30
    v_cvt_pk_bf16_f32 v31, v31, v31
    v_cvt_pk_bf16_f32 v32, v32, v32
    v_cvt_pk_bf16_f32 v33, v33, v33
    v_cvt_pk_bf16_f32 v34, v34, v34
    v_cvt_pk_bf16_f32 v35, v35, v35
    v_cvt_pk_bf16_f32 v36, v36, v36
    v_cvt_pk_bf16_f32 v37, v37, v37
    s_waitcnt lgkmcnt(0)
    s_mul_i32 s64, s64, 1664525
    s_add_u32 s64, s64, 1013904223
    s_bfe_u32 s65, s64, 524288
    s_bfe_u32 s66, s64, 524296
    s_bfe_u32 s67, s64, 524304
    s_bfe_u32 s68, s64, 524312
    s_cmp_ge_u32 s5, 6
    s_cbranch_scc1 L_hmB
    s_lshl_b32 s53, s6, 10
    s_add_u32 s53, s53, 65536
    v_and_b32 v52, v28, v24
    v_and_b32 v53, v28, v25
    v_and_b32 v54, v28, v26
    v_and_b32 v55, v28, v27
    s_waitcnt vmcnt(9)
    s_nop 0
    v_mfma_f32_16x16x32_bf16 v[40:43], v[52:55], v[64:67], 0
    v_and_b32 v56, v29, v24
    v_and_b32 v57, v29, v25
    v_and_b32 v58, v29, v26
    v_and_b32 v59, v29, v27
    s_waitcnt vmcnt(8)
    s_nop 0
    v_mfma_f32_16x16x32_bf16 v[40:43], v[56:59], v[68:71], v[40:43]
    v_and_b32 v52, v30, v24
    v_and_b32 v53, v30, v25
    v_and_b32 v54, v30, v26
    v_and_b32 v55, v30, v27
    s_waitcnt vmcnt(7)
    s_nop 0
    v_mfma_f32_16x16x32_bf16 v[40:43], v[52:55], v[72:75], v[40:43]
    v_and_b32 v56, v31, v24
    v_and_b32 v57, v31, v25
    v_and_b32 v58, v31, v26
    v_and_b32 v59, v31, v27
    s_waitcnt vmcnt(6)
    s_nop 0
    v_mfma_f32_16x16x32_bf16 v[40:43], v[56:59], v[76:79], v[40:43]
    v_and_b32 v52, v32, v24
    v_and_b32 v53, v32, v25
    v_and_b32 v54, v32, v26
    v_and_b32 v55, v32, v27
    s_waitcnt vmcnt(5)
    s_nop 0
    v_mfma_f32_16x16x32_bf16 v[40:43], v[52:55], v[80:83], v[40:43]
    v_and_b32 v56, v33, v24
    v_and_b32 v57, v33, v25
    v_and_b32 v58, v33, v26
    v_and_b32 v59, v33, v27
    s_waitcnt vmcnt(4)
    s_nop 0
    v_mfma_f32_16x16x32_bf16 v[40:43], v[56:59], v[84:87], v[40:43]
    v_and_b32 v52, v34, v24
    v_and_b32 v53, v34, v25
    v_and_b32 v54, v34, v26
    v_and_b32 v55, v34, v27
    s_waitcnt vmcnt(3)
    s_nop 0
    v_mfma_f32_16x16x32_bf16 v[40:43], v[52:55], v[88:91], v[40:43]
    v_and_b32 v56, v35, v24
    v_and_b32 v57, v35, v25
    v_and_b32 v58, v35, v26
    v_and_b32 v59, v35, v27
    s_waitcnt vmcnt(2)
    s_nop 0
    v_mfma_f32_16x16x32_bf16 v[40:43], v[56:59], v[92:95], v[40:43]
    v_and_b32 v52, v36, v24
    v_and_b32 v53, v36, v25
    v_and_b32 v54, v36, v26
    v_and_b32 v55, v36, v27
    s_waitcnt vmcnt(1)
    s_nop 0
    v_mfma_f32_16x16x32_bf16 v[40:43], v[52:55], v[96:99], v[40:43]
    v_and_b32 v56, v37, v24
    v_and_b32 v57, v37, v25
    v_and_b32 v58, v37, v26
    v_and_b32 v59, v37, v27
    s_waitcnt vmcnt(0)
    s_nop 0
    v_mfma_f32_16x16x32_bf16 v[40:43], v[56:59], v[100:103], v[40:43]
    s_mov_b32 exec_lo, 0x00ff00ff
    s_mov_b32 exec_hi, 0xff00ff00
    s_nop 5
    ds_write_b128 v20, v[40:43] offset:1536
    s_branch L_hred
L_hmB:
    s_lshl_b32 s53, s60, 3
    s_and_b32 s54, s5, 1
    s_lshl_b32 s54, s54, 2
    s_add_u32 s53, s53, s54
    s_add_u32 s53, s53, s61
    s_lshl_b32 s53, s53, 11
    s_add_u32 s53, s53, 327680
    s_bitcmp0_b32 s7, 0
    s_cbranch_scc1 L_hmB2
    v_mov_b32 v28, v33
    v_mov_b32 v29, v34
    v_mov_b32 v30, v35
    v_mov_b32 v31, v36
    v_mov_b32 v32, v37
L_hmB2:
    v_and_b32 v52, v28, v24
    v_and_b32 v53, v28, v25
    v_and_b32 v54, v28, v26
    v_and_b32 v55, v28, v27
    s_waitcnt vmcnt(12)
    s_nop 0
    v_mfma_f32_16x16x32_bf16 v[40:43], v[52:55], v[64:67], 0
    v_mfma_f32_16x16x32_bf16 v[44:47], v[52:55], v[68:71], 0
    v_mfma_f32_16x16x32_bf16 v[48:51], v[52:55], v[72:75], 0
    v_and_b32 v56, v29, v24
    v_and_b32 v57, v29, v25
    v_and_b32 v58, v29, v26
    v_and_b32 v59, v29, v27
    s_waitcnt vmcnt(9)
    s_nop 0
    v_mfma_f32_16x16x32_bf16 v[40:43], v[56:59], v[76:79], v[40:43]
    v_mfma_f32_16x16x32_bf16 v[44:47], v[56:59], v[80:83], v[44:47]
    v_mfma_f32_16x16x32_bf16 v[48:51], v[56:59], v[84:87], v[48:51]
    v_and_b32 v52, v30, v24
    v_and_b32 v53, v30, v25
    v_and_b32 v54, v30, v26
    v_and_b32 v55, v30, v27
    s_waitcnt vmcnt(6)
    s_nop 0
    v_mfma_f32_16x16x32_bf16 v[40:43], v[52:55], v[88:91], v[40:43]
    v_mfma_f32_16x16x32_bf16 v[44:47], v[52:55], v[92:95], v[44:47]
    v_mfma_f32_16x16x32_bf16 v[48:51], v[52:55], v[96:99], v[48:51]
    v_and_b32 v56, v31, v24
    v_and_b32 v57, v31, v25
    v_and_b32 v58, v31, v26
    v_and_b32 v59, v31, v27
    s_waitcnt vmcnt(3)
    s_nop 0
    v_mfma_f32_16x16x32_bf16 v[40:43], v[56:59], v[100:103], v[40:43]
    v_mfma_f32_16x16x32_bf16 v[44:47], v[56:59], v[104:107], v[44:47]
    v_mfma_f32_16x16x32_bf16 v[48:51], v[56:59], v[108:111], v[48:51]
    v_and_b32 v52, v32, v24
    v_and_b32 v53, v32, v25
    v_and_b32 v54, v32, v26
    v_and_b32 v55, v32, v27
    s_waitcnt vmcnt(0)
    s_nop 0
    v_mfma_f32_16x16x32_bf16 v[40:43], v[52:55], v[112:115], v[40:43]
    v_mfma_f32_16x16x32_bf16 v[44:47], v[52:55], v[116:119], v[44:47]
    v_mfma_f32_16x16x32_bf16 v[48:51], v[52:55], v[120:123], v[48:51]
    s_mov_b32 exec_lo, 0x00ff00ff
    s_mov_b32 exec_hi, 0xff00ff00
    s_nop 3
    ds_write_b128 v20, v[40:43] offset:1536
    ds_write_b128 v20, v[44:47] offset:3584
    ds_write_b128 v20, v[48:51] offset:5632
L_hred:
    s_mov_b64 exec, -1
    ds_write_b32 v19, v7 offset:512
    ds_read_b32 v8, v23 offset:512
    ds_read2st64_b32 v[40:41], v21 offset0:6 offset1:7
    ds_read2st64_b32 v[42:43], v21 offset0:8 offset1:9
    ds_read2st64_b32 v[44:45], v21 offset0:10 offset1:11
    ds_read2st64_b32 v[46:47], v21 offset0:12 offset1:13
    s_waitcnt lgkmcnt(0)
    v_cmp_eq_u32 vcc, 0, v8
    s_cbranch_vccnz L_hnopub
    v_pk_add_f32 v[40:41], v[40:41], v[42:43]
    v_pk_add_f32 v[44:45], v[44:45], v[46:47]
    v_pk_add_f32 v[40:41], v[40:41], v[44:45]
    v_add_f32 v40, v40, v41
    v_mov_b32 v41, s64
    buffer_store_dwordx2 v[40:41], v22, s[48:51], s53 offen offset:0 sc1
    s_cmp_lt_u32 s5, 6
    s_cbranch_scc1 L_hnopub
    ds_read2st64_b32 v[48:49], v21 offset0:14 offset1:15
    ds_read2st64_b32 v[50:51], v21 offset0:16 offset1:17
    ds_read2st64_b32 v[52:53], v21 offset0:18 offset1:19
    ds_read2st64_b32 v[54:55], v21 offset0:20 offset1:21
    ds_read2st64_b32 v[56:57], v21 offset0:22 offset1:23
    ds_read2st64_b32 v[58:59], v21 offset0:24 offset1:25
    ds_read2st64_b32 v[60:61], v21 offset0:26 offset1:27
    ds_read2st64_b32 v[62:63], v21 offset0:28 offset1:29
    s_waitcnt lgkmcnt(0)
    v_pk_add_f32 v[48:49], v[48:49], v[50:51]
    v_pk_add_f32 v[52:53], v[52:53], v[54:55]
    v_pk_add_f32 v[48:49], v[48:49], v[52:53]
    v_add_f32 v48, v48, v49
    v_mov_b32 v49, s64
    buffer_store_dwordx2 v[48:49], v22, s[48:51], s53 offen offset:512 sc1
    v_pk_add_f32 v[56:57], v[56:57], v[58:59]
    v_pk_add_f32 v[60:61], v[60:61], v[62:63]
    v_pk_add_f32 v[56:57], v[56:57], v[60:61]
    v_add_f32 v56, v56, v57
    v_mov_b32 v57, s64
    buffer_store_dwordx2 v[56:57], v22, s[48:51], s53 offen offset:1024 sc1
L_hnopub:
    v_and_b32 v19, 28, v21
    s_cmp_lg_u32 s7, 0
    s_cbranch_scc1 L_hy
    v_lshrrev_b32 v6, 5, v0
    v_and_b32 v8, 31, v0
    v_lshlrev_b32 v6, 10, v6
    v_lshl_add_u32 v6, v8, 4, v6
    s_lshl_b32 s53, s4, 13
    s_add_u32 s53, s53, 65536
    s_add_u32 s54, s53, 4096
    v_mov_b32 v8, 0
    s_sleep 64
    s_mov_b32 s57, 32768
    buffer_load_dwordx4 v[64:67], v6, s[48:51], s53 offen sc1
    buffer_load_dwordx4 v[68:71], v6, s[48:51], s53 offen offset:2048 sc1
    buffer_load_dwordx4 v[72:75], v6, s[48:51], s54 offen sc1
L_pq:
    s_waitcnt vmcnt(0)
    v_xor_b32 v65, s64, v65
    v_xor_b32 v67, s64, v67
    v_xor_b32 v69, s64, v69
    v_xor_b32 v71, s64, v71
    v_xor_b32 v73, s64, v73
    v_xor_b32 v75, s64, v75
    v_or3_b32 v65, v65, v67, v69
    v_or3_b32 v71, v71, v73, v75
    v_or_b32 v65, v65, v71
    v_cmp_ne_u32 vcc, 0, v65
    s_cbranch_vccz L_pq_d0
    s_sleep 8
    buffer_load_dwordx4 v[64:67], v6, s[48:51], s53 offen sc1
    buffer_load_dwordx4 v[68:71], v6, s[48:51], s53 offen offset:2048 sc1
    buffer_load_dwordx4 v[72:75], v6, s[48:51], s54 offen sc1
    s_sub_u32 s57, s57, 1
    s_cbranch_scc0 L_pq
    s_waitcnt vmcnt(0)
L_pq_d0:
    s_nop 1
    v_permlane32_swap_b32 v64, v65
    v_permlane32_swap_b32 v66, v67
    v_permlane32_swap_b32 v68, v69
    v_permlane32_swap_b32 v70, v71
    v_permlane32_swap_b32 v72, v73
    v_permlane32_swap_b32 v74, v75
    v_add_f32 v40, v64, v65
    v_add_f32 v41, v66, v67
    v_add_f32 v42, v68, v69
    v_add_f32 v43, v70, v71
    v_add_f32 v44, v72, v73
    v_add_f32 v45, v74, v75
L_pq_done:
    s_nop 1
    v_cvt_pk_bf16_f32 v40, v40, v41
    v_cvt_pk_bf16_f32 v42, v42, v43
    v_cvt_pk_bf16_f32 v44, v44, v45
    s_mov_b32 exec_hi, 0
    ds_write_b32 v21, v40 offset:0
    ds_write_b32 v21, v42 offset:128
    ds_write_b32 v21, v44 offset:256
    v_mov_b32 v12, 1
    v_mov_b32 v13, s64
    ds_write_b64 v8, v[12:13] offset:528
    s_mov_b32 exec_hi, -1
    v_lshlrev_b32 v6, 4, v0
    s_mul_i32 s58, s2, 2
    v_and_b32 v9, 3, v0
    v_add_u32 v9, s58, v9
    v_bfe_u32 v10, v0, 2, 1
    v_bfe_u32 v12, v0, 3, 1
    v_lshl_add_u32 v10, v10, 1, v12
    v_bfe_u32 v12, v9, 4, 1
    v_lshl_add_u32 v10, v12, 2, v10
    v_and_b32 v12, 15, v9
    v_lshl_add_u32 v10, v12, 3, v10
    v_lshrrev_b32 v12, 5, v9
    v_lshl_add_u32 v10, v12, 7, v10
    v_lshlrev_b32 v10, 1, v10
    buffer_load_ushort v9, v10, s[8:11], 0 offen
    s_lshl_b32 s53, s4, 10
    s_add_u32 s53, s53, 458752
    v_lshrrev_b32 v11, 4, v0
    v_and_b32 v12, 15, v0
    v_lshlrev_b32 v11, 11, v11
    v_lshl_add_u32 v11, v12, 4, v11
    s_lshl_b32 s54, s4, 13
    s_lshl_b32 s55, s5, 8
    s_add_u32 s54, s54, s55
    s_add_u32 s54, s54, 524288
    v_mov_b32 v23, 0xffffff00
    s_mov_b32 s57, 262144
L_wml:
    ds_read_b32 v12, v19 offset:544
    s_sub_u32 s57, s57, 1
    s_cbranch_scc1 L_wml_done
    s_waitcnt lgkmcnt(0)
    v_cmp_eq_u32 vcc, 0, v12
    s_cbranch_vccz L_wml_done
    s_sleep 4
    s_branch L_wml
L_wml_done:
    s_waitcnt lgkmcnt(0)
    s_sleep 32
    s_mov_b32 s57, 32768
    buffer_load_dwordx4 v[112:115], v6, s[48:51], s53 offen sc1
L_pml:
    s_waitcnt vmcnt(0)
    v_cmp_ne_u32 vcc, s64, v114
    s_cbranch_vccz L_pml_d0
    s_sleep 8
    buffer_load_dwordx4 v[112:115], v6, s[48:51], s53 offen sc1
    s_sub_u32 s57, s57, 1
    s_cbranch_scc0 L_pml
    s_waitcnt vmcnt(0)
L_pml_d0:
    s_nop 1
    v_mov_b32 v12, v112
    v_mov_b32 v14, v112
    v_mov_b32 v13, v113
    s_getreg_b32 s62, hwreg(HW_REG_XCC_ID, 0, 4)
    v_cmp_ne_u32 vcc, s62, v115
    s_nop 0
    s_or_b32 s63, vcc_lo, vcc_hi
L_pml_done:
    s_nop 1
    v_max_f32_dpp v14, v14, v14 quad_perm:[1,0,3,2] row_mask:0xf bank_mask:0xf
    s_nop 1
    v_max_f32_dpp v14, v14, v14 quad_perm:[2,3,0,1] row_mask:0xf bank_mask:0xf
    s_nop 1
    v_max_f32_dpp v14, v14, v14 row_half_mirror row_mask:0xf bank_mask:0xf
    s_nop 1
    v_max_f32_dpp v14, v14, v14 row_ror:8 row_mask:0xf bank_mask:0xf
    s_nop 1
    v_max_f32_dpp v14, v14, v14 row_bcast:15 row_mask:0xa bank_mask:0xf
    s_nop 1
    v_max_f32_dpp v14, v14, v14 row_bcast:31 row_mask:0xc bank_mask:0xf
    s_nop 0
    v_readlane_b32 s56, v14, 63
    s_nop 1
    v_subrev_f32 v12, s56, v12
    v_mul_f32 v12, 0x3fb8aa3b, v12
    v_exp_f32 v12, v12
    s_nop 0
    v_mul_f32 v13, v13, v12
    s_nop 1
    v_add_f32_dpp v13, v13, v13 quad_perm:[1,0,3,2] row_mask:0xf bank_mask:0xf
    s_nop 1
    v_add_f32_dpp v13, v13, v13 quad_perm:[2,3,0,1] row_mask:0xf bank_mask:0xf
    s_nop 1
    v_add_f32_dpp v13, v13, v13 row_half_mirror row_mask:0xf bank_mask:0xf
    s_nop 1
    v_add_f32_dpp v13, v13, v13 row_ror:8 row_mask:0xf bank_mask:0xf
    s_nop 1
    v_add_f32_dpp v13, v13, v13 row_bcast:15 row_mask:0xa bank_mask:0xf
    s_nop 1
    v_add_f32_dpp v13, v13, v13 row_bcast:31 row_mask:0xc bank_mask:0xf
    v_rcp_f32 v13, v13
    s_nop 0
    v_readlane_b32 s56, v13, 63
    s_nop 1
    v_mul_f32 v12, s56, v12
    ds_write_b32 v21, v12 offset:1024
    ds_write_b32 v8, v7 offset:536
    s_mul_i32 s53, s2, 4096
    s_add_u32 s53, s53, 786432
    s_add_u32 s55, s53, 4096
    v_lshlrev_b32 v9, 16, v9
    v_mov_b32 v63, s64
    s_mov_b32 exec_hi, 0xffff
    s_mov_b32 s57, 262144
L_wv0:
    ds_read_b32 v12, v19 offset:576
    s_sub_u32 s57, s57, 1
    s_cbranch_scc1 L_wv0_done
    s_waitcnt lgkmcnt(0)
    v_cmp_eq_u32 vcc, 0, v12
    s_cbranch_vccz L_wv0_done
    s_sleep 4
    s_branch L_wv0
L_wv0_done:
    s_waitcnt lgkmcnt(0)
    s_mov_b32 s57, 262144
L_wd0:
    ds_read_b32 v12, v19 offset:672
    s_sub_u32 s57, s57, 1
    s_cbranch_scc1 L_wd0_done
    s_waitcnt lgkmcnt(0)
    v_cmp_eq_u32 vcc, 0, v12
    s_cbranch_vccz L_wd0_done
    s_branch L_wd0
L_wd0_done:
    s_waitcnt lgkmcnt(0)
    ds_read_b128 v[64:67], v6 offset:7680
    ds_read_b128 v[68:71], v6 offset:8448
    ds_read_b128 v[72:75], v6 offset:9216
    ds_read_b128 v[76:79], v6 offset:9984
    ds_read_b128 v[80:83], v6 offset:10752
    ds_read_b128 v[84:87], v6 offset:11520
    ds_read_b128 v[88:91], v6 offset:12288
    ds_read_b128 v[92:95], v6 offset:13056
    ds_read_b128 v[96:99], v6 offset:13824
    ds_read_b128 v[100:103], v6 offset:14592
    ds_read_b128 v[104:107], v6 offset:15360
    ds_read_b128 v[108:111], v6 offset:16128
    ds_read_b128 v[112:115], v6 offset:16896
    ds_read_b128 v[116:119], v6 offset:17664
    ds_read_b128 v[120:123], v6 offset:18432
    ds_read_b128 v[124:127], v6 offset:19200
    s_cmp_lg_u32 s63, 0
    s_waitcnt lgkmcnt(13)
    v_pk_add_f32 v[64:65], v[64:65], v[72:73]
    v_pk_add_f32 v[66:67], v[66:67], v[74:75]
    s_waitcnt lgkmcnt(12)
    v_pk_add_f32 v[68:69], v[68:69], v[76:77]
    v_pk_add_f32 v[70:71], v[70:71], v[78:79]
    s_waitcnt lgkmcnt(11)
    v_pk_add_f32 v[64:65], v[64:65], v[80:81]
    v_pk_add_f32 v[66:67], v[66:67], v[82:83]
    s_waitcnt lgkmcnt(10)
    v_pk_add_f32 v[68:69], v[68:69], v[84:85]
    v_pk_add_f32 v[70:71], v[70:71], v[86:87]
    s_waitcnt lgkmcnt(9)
    v_pk_add_f32 v[64:65], v[64:65], v[88:89]
    v_pk_add_f32 v[66:67], v[66:67], v[90:91]
    s_waitcnt lgkmcnt(8)
    v_pk_add_f32 v[68:69], v[68:69], v[92:93]
    v_pk_add_f32 v[70:71], v[70:71], v[94:95]
    s_waitcnt lgkmcnt(7)
    v_pk_add_f32 v[64:65], v[64:65], v[96:97]
    v_pk_add_f32 v[66:67], v[66:67], v[98:99]
    s_waitcnt lgkmcnt(6)
    v_pk_add_f32 v[68:69], v[68:69], v[100:101]
    v_pk_add_f32 v[70:71], v[70:71], v[102:103]
    s_waitcnt lgkmcnt(5)
    v_pk_add_f32 v[64:65], v[64:65], v[104:105]
    v_pk_add_f32 v[66:67], v[66:67], v[106:107]
    s_waitcnt lgkmcnt(4)
    v_pk_add_f32 v[68:69], v[68:69], v[108:109]
    v_pk_add_f32 v[70:71], v[70:71], v[110:111]
    s_waitcnt lgkmcnt(3)
    v_pk_add_f32 v[64:65], v[64:65], v[112:113]
    v_pk_add_f32 v[66:67], v[66:67], v[114:115]
    s_waitcnt lgkmcnt(2)
    v_pk_add_f32 v[68:69], v[68:69], v[116:117]
    v_pk_add_f32 v[70:71], v[70:71], v[118:119]
    s_waitcnt lgkmcnt(1)
    v_pk_add_f32 v[64:65], v[64:65], v[120:121]
    v_pk_add_f32 v[66:67], v[66:67], v[122:123]
    s_waitcnt lgkmcnt(0)
    v_pk_add_f32 v[68:69], v[68:69], v[124:125]
    v_pk_add_f32 v[70:71], v[70:71], v[126:127]
    v_pk_add_f32 v[64:65], v[64:65], v[68:69]
    v_pk_add_f32 v[66:67], v[66:67], v[70:71]
    v_and_or_b32 v64, v64, v23, s65
    v_and_or_b32 v65, v65, v23, s66
    v_and_or_b32 v66, v66, v23, s67
    v_and_or_b32 v67, v67, v23, s68
    s_cbranch_scc1 L_os1
    buffer_store_dwordx4 v[64:67], v11, s[48:51], s54 offen
    s_branch L_os2
L_os1:
    buffer_store_dwordx4 v[64:67], v11, s[48:51], s54 offen sc1
L_os2:
    s_mov_b32 exec_hi, -1
    s_cmp_ge_u32 s2, 80
    s_cbranch_scc1 L_fin
    ds_read_b32 v12, v8 offset:704
    s_waitcnt lgkmcnt(0)
    v_readfirstlane_b32 s46, v12
    s_nop 0
    s_cmp_lg_u32 s46, 0
    s_cselect_b32 s69, s46, s69
    s_sleep 56
L_yt:
    s_memrealtime s[46:47]
    s_waitcnt lgkmcnt(0)
    s_sub_u32 s46, s46, s69
    s_cmp_ge_i32 s46, 1904
    s_cbranch_scc1 L_yt_d
    s_sleep 1
    s_branch L_yt
L_yt_d:
    s_mov_b32 s57, 32768
    buffer_load_dwordx4 v[72:75], v6, s[48:51], s53 offen offset:0 sc1
    buffer_load_dwordx4 v[76:79], v6, s[48:51], s53 offen offset:1024 sc1
    buffer_load_dwordx4 v[80:83], v6, s[48:51], s53 offen offset:2048 sc1
    buffer_load_dwordx4 v[84:87], v6, s[48:51], s53 offen offset:3072 sc1
L_py:
    s_waitcnt vmcnt(3)
    v_xor_b32 v72, s65, v72
    v_xor_b32 v73, s66, v73
    v_xor_b32 v74, s67, v74
    v_xor_b32 v75, s68, v75
    v_or3_b32 v14, v72, v73, v74
    v_or_b32 v14, v14, v75
    s_waitcnt vmcnt(2)
    v_xor_b32 v76, s65, v76
    v_xor_b32 v77, s66, v77
    v_xor_b32 v78, s67, v78
    v_xor_b32 v79, s68, v79
    v_or3_b32 v14, v14, v76, v77
    v_or3_b32 v14, v14, v78, v79
    v_pk_add_f32 v[40:41], v[72:73], v[76:77]
    v_pk_add_f32 v[42:43], v[74:75], v[78:79]
    s_waitcnt vmcnt(1)
    v_xor_b32 v80, s65, v80
    v_xor_b32 v81, s66, v81
    v_xor_b32 v82, s67, v82
    v_xor_b32 v83, s68, v83
    v_or3_b32 v14, v14, v80, v81
    v_or3_b32 v14, v14, v82, v83
    v_pk_add_f32 v[40:41], v[40:41], v[80:81]
    v_pk_add_f32 v[42:43], v[42:43], v[82:83]
    s_waitcnt vmcnt(0)
    v_xor_b32 v84, s65, v84
    v_xor_b32 v85, s66, v85
    v_xor_b32 v86, s67, v86
    v_xor_b32 v87, s68, v87
    v_or3_b32 v14, v14, v84, v85
    v_or3_b32 v14, v14, v86, v87
    v_pk_add_f32 v[40:41], v[40:41], v[84:85]
    v_pk_add_f32 v[42:43], v[42:43], v[86:87]
    v_and_b32 v14, 0xff, v14
    v_cmp_ne_u32 vcc, 0, v14
    s_cbranch_vccz L_py_d0
    buffer_load_dwordx4 v[72:75], v6, s[48:51], s53 offen offset:0 sc1
    buffer_load_dwordx4 v[76:79], v6, s[48:51], s53 offen offset:1024 sc1
    buffer_load_dwordx4 v[80:83], v6, s[48:51], s53 offen offset:2048 sc1
    buffer_load_dwordx4 v[84:87], v6, s[48:51], s53 offen offset:3072 sc1
    s_sub_u32 s57, s57, 1
    s_cbranch_scc0 L_py
    s_waitcnt vmcnt(0)
L_py_d0:
    s_nop 1
L_py_done:
    s_nop 1
    v_add_f32_dpp v44, v40, v40 row_ror:8 row_mask:0xf bank_mask:0x3
    v_add_f32_dpp v45, v42, v42 row_ror:8 row_mask:0xf bank_mask:0x3
    s_nop 0
    v_add_f32_dpp v44, v41, v41 row_ror:8 row_mask:0xf bank_mask:0xc
    v_add_f32_dpp v45, v43, v43 row_ror:8 row_mask:0xf bank_mask:0xc
    s_nop 0
    v_add_f32_dpp v46, v44, v44 row_shl:4 row_mask:0xf bank_mask:0x5
    s_nop 1
    v_add_f32_dpp v46, v45, v45 row_shr:4 row_mask:0xf bank_mask:0xa
    s_nop 1
    v_add_f32_dpp v46, v46, v46 quad_perm:[2,3,0,1] row_mask:0xf bank_mask:0xf
    v_mov_b32 v44, v46
    s_nop 1
    v_permlane32_swap_b32 v44, v45
    v_mov_b32 v44, v46
    s_nop 1
    v_permlane16_swap_b32 v44, v47
    v_add_f32 v46, v46, v45
    v_permlane16_swap_b32 v45, v15
    v_add_f32 v46, v46, v47
    v_cvt_pk_bf16_f32 v46, v46, v15
    v_and_b32 v15, 0xffff0000, v46
    v_lshlrev_b32 v46, 16, v46
    v_add_f32 v46, v46, v9
    v_cvt_pk_bf16_f32 v46, v46, v46
    v_lshlrev_b32 v46, 16, v46
    v_add_f32 v46, v46, v15
    v_cvt_pk_bf16_f32 v46, v46, v46
    s_mov_b64 exec, 13107
    buffer_store_short v46, v10, s[40:43], 0 offen
    s_cmp_lg_u32 s2, 0
    s_cbranch_scc1 L_fin
    s_mov_b64 exec, 1
    buffer_store_dword v63, v8, s[48:51], 0 offen sc1
    s_branch L_fin
L_hy:
    v_and_b32 v10, 8, v0
    v_cmp_eq_u32 vcc, 0, v10
    s_nop 1
    v_cndmask_b32 v24, 0, v24, vcc
    v_cndmask_b32 v25, 0, v25, vcc
    v_cndmask_b32 v26, 0, v26, vcc
    v_cndmask_b32 v27, 0, v27, vcc
    v_lshrrev_b32 v4, 4, v0
    v_and_b32 v5, 15, v0
    v_mov_b32 v23, 0xffffff00
    v_lshrrev_b32 v11, 1, v0
    v_lshlrev_b32 v11, 12, v11
    v_and_b32 v10, 1, v0
    v_lshl_add_u32 v11, v10, 4, v11
    s_lshl_b32 s56, s4, 1
    s_lshr_b32 s58, s56, 4
    s_lshl_b32 s58, s58, 10
    s_and_b32 s56, s56, 15
    s_lshl_b32 s56, s56, 4
    s_add_u32 s56, s56, s58
    s_add_u32 s56, s56, 786432
    s_cmp_lg_u32 s7, 3
    s_cbranch_scc1 L_hy_y
    s_cmp_ge_u32 s5, 5
    s_cbranch_scc1 L_fin
    s_lshl_b32 s58, s5, 16
    s_add_u32 s56, s56, s58
    s_add_u32 s56, s56, 768
    v_mul_u32_u24 v6, 15360, v4
    v_lshl_add_u32 v6, v5, 4, v6
    s_mul_i32 s62, s4, 61440
    s_lshl_b32 s58, s5, 8
    s_add_u32 s62, s62, s58
    v_lshlrev_b32 v8, 11, v1
    v_lshl_add_u32 v8, v2, 4, v8
    s_lshl_b32 s53, s60, 14
    s_mul_i32 s54, s61, 384
    s_add_u32 s53, s53, s54
    s_add_u32 s53, s53, 327680
    v_mul_u32_u24 v7, 48, v4
    v_lshlrev_b32 v10, 3, v0
L_gt:
    s_memrealtime s[46:47]
    s_waitcnt lgkmcnt(0)
    s_sub_u32 s46, s46, s69
    s_cmp_ge_i32 s46, 900
    s_cbranch_scc1 L_gt_d
    s_sleep 4
    s_branch L_gt
L_gt_d:
    s_mov_b32 s57, 32768
    buffer_load_dwordx4 v[40:43], v8, s[48:51], s53 offen offset:0 sc1
    buffer_load_dwordx4 v[44:47], v8, s[48:51], s53 offen offset:128 sc1
    buffer_load_dwordx4 v[48:51], v8, s[48:51], s53 offen offset:256 sc1
L_pg:
    s_waitcnt vmcnt(0)
    v_xor_b32 v41, s64, v41
    v_xor_b32 v43, s64, v43
    v_xor_b32 v45, s64, v45
    v_xor_b32 v47, s64, v47
    v_xor_b32 v49, s64, v49
    v_xor_b32 v51, s64, v51
    v_or3_b32 v41, v41, v43, v45
    v_or3_b32 v47, v47, v49, v51
    v_or_b32 v41, v41, v47
    v_cmp_ne_u32 vcc, 0, v41
    s_cbranch_vccz L_pg_d0
    s_sleep 16
    buffer_load_dwordx4 v[40:43], v8, s[48:51], s53 offen offset:0 sc1
    buffer_load_dwordx4 v[44:47], v8, s[48:51], s53 offen offset:128 sc1
    buffer_load_dwordx4 v[48:51], v8, s[48:51], s53 offen offset:256 sc1
    s_sub_u32 s57, s57, 1
    s_cbranch_scc0 L_pg
    s_waitcnt vmcnt(0)
L_pg_d0:
    s_nop 1
L_pg_done:
    s_nop 1
    v_add_f32_dpp v40, v40, v40 row_ror:8 row_mask:0xf bank_mask:0xf
    v_add_f32_dpp v42, v42, v42 row_ror:8 row_mask:0xf bank_mask:0xf
    v_add_f32_dpp v44, v44, v44 row_ror:8 row_mask:0xf bank_mask:0xf
    v_add_f32_dpp v46, v46, v46 row_ror:8 row_mask:0xf bank_mask:0xf
    v_add_f32_dpp v48, v48, v48 row_ror:8 row_mask:0xf bank_mask:0xf
    v_add_f32_dpp v50, v50, v50 row_ror:8 row_mask:0xf bank_mask:0xf
    v_mov_b32 v41, v40
    v_mov_b32 v43, v42
    v_mov_b32 v45, v44
    v_mov_b32 v47, v46
    v_mov_b32 v49, v48
    v_mov_b32 v51, v50
    v_permlane16_swap_b32 v41, v28
    v_permlane16_swap_b32 v43, v29
    v_permlane16_swap_b32 v45, v30
    v_permlane16_swap_b32 v47, v31
    v_permlane16_swap_b32 v49, v32
    v_permlane16_swap_b32 v51, v33
    v_add_f32 v40, v40, v28
    v_add_f32 v42, v42, v29
    v_add_f32 v44, v44, v30
    v_add_f32 v46, v46, v31
    v_add_f32 v48, v48, v32
    v_add_f32 v50, v50, v33
    v_mov_b32 v28, v40
    v_mov_b32 v29, v42
    v_mov_b32 v30, v44
    v_mov_b32 v31, v46
    v_mov_b32 v32, v48
    v_mov_b32 v33, v50
    v_permlane32_swap_b32 v28, v41
    v_permlane32_swap_b32 v29, v43
    v_permlane32_swap_b32 v30, v45
    v_permlane32_swap_b32 v31, v47
    v_permlane32_swap_b32 v32, v49
    v_permlane32_swap_b32 v33, v51
    v_cvt_pk_bf16_f32 v40, v40, v41
    v_cvt_pk_bf16_f32 v42, v42, v43
    v_cvt_pk_bf16_f32 v44, v44, v45
    v_cvt_pk_bf16_f32 v46, v46, v47
    v_cvt_pk_bf16_f32 v48, v48, v49
    v_cvt_pk_bf16_f32 v50, v50, v51
    v_and_b32 v41, 0xffff0000, v40
    v_and_b32 v43, 0xffff0000, v42
    v_and_b32 v45, 0xffff0000, v44
    v_and_b32 v47, 0xffff0000, v46
    v_and_b32 v49, 0xffff0000, v48
    v_and_b32 v51, 0xffff0000, v50
    v_lshlrev_b32 v40, 16, v40
    v_lshlrev_b32 v42, 16, v42
    v_lshlrev_b32 v44, 16, v44
    v_lshlrev_b32 v46, 16, v46
    v_lshlrev_b32 v48, 16, v48
    v_lshlrev_b32 v50, 16, v50
    v_mul_f32 v40, 0xbfb8aa3b, v40
    v_mul_f32 v42, 0xbfb8aa3b, v42
    v_mul_f32 v44, 0xbfb8aa3b, v44
    v_mul_f32 v46, 0xbfb8aa3b, v46
    v_mul_f32 v48, 0xbfb8aa3b, v48
    v_mul_f32 v50, 0xbfb8aa3b, v50
    v_exp_f32 v40, v40
    v_exp_f32 v42, v42
    v_exp_f32 v44, v44
    v_exp_f32 v46, v46
    v_exp_f32 v48, v48
    v_exp_f32 v50, v50
    v_add_f32 v40, 1.0, v40
    v_add_f32 v42, 1.0, v42
    v_add_f32 v44, 1.0, v44
    v_add_f32 v46, 1.0, v46
    v_add_f32 v48, 1.0, v48
    v_add_f32 v50, 1.0, v50
    v_rcp_f32 v40, v40
    v_rcp_f32 v42, v42
    v_rcp_f32 v44, v44
    v_rcp_f32 v46, v46
    v_rcp_f32 v48, v48
    v_rcp_f32 v50, v50
    v_cvt_pk_bf16_f32 v40, v40, v40
    v_cvt_pk_bf16_f32 v42, v42, v42
    v_cvt_pk_bf16_f32 v44, v44, v44
    v_cvt_pk_bf16_f32 v46, v46, v46
    v_cvt_pk_bf16_f32 v48, v48, v48
    v_cvt_pk_bf16_f32 v50, v50, v50
    v_lshlrev_b32 v40, 16, v40
    v_lshlrev_b32 v42, 16, v42
    v_lshlrev_b32 v44, 16, v44
    v_lshlrev_b32 v46, 16, v46
    v_lshlrev_b32 v48, 16, v48
    v_lshlrev_b32 v50, 16, v50
    v_mul_f32 v40, v40, v41
    v_mul_f32 v42, v42, v43
    v_mul_f32 v44, v44, v45
    v_mul_f32 v46, v46, v47
    v_mul_f32 v48, v48, v49
    v_mul_f32 v50, v50, v51
    v_cvt_pk_bf16_f32 v28, v40, v40
    v_cvt_pk_bf16_f32 v29, v42, v42
    v_cvt_pk_bf16_f32 v30, v44, v44
    v_cvt_pk_bf16_f32 v31, v46, v46
    v_cvt_pk_bf16_f32 v32, v48, v48
    v_cvt_pk_bf16_f32 v33, v50, v50
    s_mov_b64 exec, 0xff
    ds_write_b64 v10, v[28:29] offset:768
    ds_write_b64 v10, v[30:31] offset:832
    ds_write_b64 v10, v[32:33] offset:896
    s_mov_b64 exec, -1
    ds_read_b128 v[40:43], v7 offset:768
    ds_read_b128 v[44:47], v7 offset:784
    ds_read_b128 v[48:51], v7 offset:800
    s_waitcnt lgkmcnt(0)
L_dnt1:
    s_memrealtime s[46:47]
    s_waitcnt lgkmcnt(0)
    s_sub_u32 s46, s46, s69
    s_cmp_ge_i32 s46, 1444
    s_cbranch_scc1 L_dnt1_d
    s_sleep 16
    s_branch L_dnt1
L_dnt1_d:
    v_mov_b32 v13, 0
    ds_read_b32 v12, v13 offset:704
    s_waitcnt lgkmcnt(0)
    v_readfirstlane_b32 s46, v12
    s_nop 0
    s_cmp_lg_u32 s46, 0
    s_cselect_b32 s69, s46, s69
L_dnt0:
    s_memrealtime s[46:47]
    s_waitcnt lgkmcnt(0)
    s_sub_u32 s46, s46, s69
    s_cmp_ge_i32 s46, 1614
    s_cbranch_scc1 L_dnt0_d
    s_sleep 4
    s_branch L_dnt0
L_dnt0_d:
L_dnt:
    s_memrealtime s[46:47]
    s_waitcnt lgkmcnt(0)
    s_sub_u32 s46, s46, s69
    s_cmp_ge_i32 s46, 1644
    s_cbranch_scc1 L_dnt_d
    s_sleep 1
    s_branch L_dnt
L_dnt_d:
    s_add_u32 s69, s69, 1644
    buffer_load_dwordx4 v[64:67], v6, s[36:39], s62 offen offset:0 nt
L_dnp1:
    s_memrealtime s[46:47]
    s_waitcnt lgkmcnt(0)
    s_sub_u32 s46, s46, s69
    s_cmp_ge_i32 s46, 10
    s_cbranch_scc1 L_dnp1_d
    s_sleep 1
    s_branch L_dnp1
L_dnp1_d:
    buffer_load_dwordx4 v[68:71], v6, s[36:39], s62 offen offset:1280 nt
L_dnp2:
    s_memrealtime s[46:47]
    s_waitcnt lgkmcnt(0)
    s_sub_u32 s46, s46, s69
    s_cmp_ge_i32 s46, 21
    s_cbranch_scc1 L_dnp2_d
    s_sleep 1
    s_branch L_dnp2
L_dnp2_d:
    buffer_load_dwordx4 v[72:75], v6, s[36:39], s62 offen offset:2560 nt
    s_add_u32 s62, s62, 3840
L_dnp3:
    s_memrealtime s[46:47]
    s_waitcnt lgkmcnt(0)
    s_sub_u32 s46, s46, s69
    s_cmp_ge_i32 s46, 32
    s_cbranch_scc1 L_dnp3_d
    s_sleep 1
    s_branch L_dnp3
L_dnp3_d:
    buffer_load_dwordx4 v[76:79], v6, s[36:39], s62 offen offset:0 nt
L_dnp4:
    s_memrealtime s[46:47]
    s_waitcnt lgkmcnt(0)
    s_sub_u32 s46, s46, s69
    s_cmp_ge_i32 s46, 42
    s_cbranch_scc1 L_dnp4_d
    s_sleep 1
    s_branch L_dnp4
L_dnp4_d:
    buffer_load_dwordx4 v[80:83], v6, s[36:39], s62 offen offset:1280 nt
L_dnp5:
    s_memrealtime s[46:47]
    s_waitcnt lgkmcnt(0)
    s_sub_u32 s46, s46, s69
    s_cmp_ge_i32 s46, 53
    s_cbranch_scc1 L_dnp5_d
    s_sleep 1
    s_branch L_dnp5
L_dnp5_d:
    buffer_load_dwordx4 v[84:87], v6, s[36:39], s62 offen offset:2560 nt
    s_add_u32 s62, s62, 3840
L_dnp6:
    s_memrealtime s[46:47]
    s_waitcnt lgkmcnt(0)
    s_sub_u32 s46, s46, s69
    s_cmp_ge_i32 s46, 64
    s_cbranch_scc1 L_dnp6_d
    s_sleep 1
    s_branch L_dnp6
L_dnp6_d:
    buffer_load_dwordx4 v[88:91], v6, s[36:39], s62 offen offset:0 nt
L_dnp7:
    s_memrealtime s[46:47]
    s_waitcnt lgkmcnt(0)
    s_sub_u32 s46, s46, s69
    s_cmp_ge_i32 s46, 74
    s_cbranch_scc1 L_dnp7_d
    s_sleep 1
    s_branch L_dnp7
L_dnp7_d:
    buffer_load_dwordx4 v[92:95], v6, s[36:39], s62 offen offset:1280 nt
L_dnp8:
    s_memrealtime s[46:47]
    s_waitcnt lgkmcnt(0)
    s_sub_u32 s46, s46, s69
    s_cmp_ge_i32 s46, 85
    s_cbranch_scc1 L_dnp8_d
    s_sleep 1
    s_branch L_dnp8
L_dnp8_d:
    buffer_load_dwordx4 v[96:99], v6, s[36:39], s62 offen offset:2560 nt
    s_add_u32 s62, s62, 3840
L_dnp9:
    s_memrealtime s[46:47]
    s_waitcnt lgkmcnt(0)
    s_sub_u32 s46, s46, s69
    s_cmp_ge_i32 s46, 96
    s_cbranch_scc1 L_dnp9_d
    s_sleep 1
    s_branch L_dnp9
L_dnp9_d:
    buffer_load_dwordx4 v[100:103], v6, s[36:39], s62 offen offset:0 nt
L_dnp10:
    s_memrealtime s[46:47]
    s_waitcnt lgkmcnt(0)
    s_sub_u32 s46, s46, s69
    s_cmp_ge_i32 s46, 106
    s_cbranch_scc1 L_dnp10_d
    s_sleep 1
    s_branch L_dnp10
L_dnp10_d:
    buffer_load_dwordx4 v[104:107], v6, s[36:39], s62 offen offset:1280 nt
L_dnp11:
    s_memrealtime s[46:47]
    s_waitcnt lgkmcnt(0)
    s_sub_u32 s46, s46, s69
    s_cmp_ge_i32 s46, 117
    s_cbranch_scc1 L_dnp11_d
    s_sleep 1
    s_branch L_dnp11
L_dnp11_d:
    buffer_load_dwordx4 v[108:111], v6, s[36:39], s62 offen offset:2560 nt
    v_and_b32 v28, v40, v24
    v_and_b32 v29, v40, v25
    v_and_b32 v30, v40, v26
    v_and_b32 v31, v40, v27
    s_waitcnt vmcnt(11)
    s_nop 0
    v_mfma_f32_16x16x32_bf16 v[16:19], v[28:31], v[64:67], 0
    v_and_b32 v32, v41, v24
    v_and_b32 v33, v41, v25
    v_and_b32 v34, v41, v26
    v_and_b32 v35, v41, v27
    s_waitcnt vmcnt(10)
    s_nop 0
    v_mfma_f32_16x16x32_bf16 v[16:19], v[32:35], v[68:71], v[16:19]
    v_and_b32 v28, v42, v24
    v_and_b32 v29, v42, v25
    v_and_b32 v30, v42, v26
    v_and_b32 v31, v42, v27
    s_waitcnt vmcnt(9)
    s_nop 0
    v_mfma_f32_16x16x32_bf16 v[16:19], v[28:31], v[72:75], v[16:19]
    v_and_b32 v32, v43, v24
    v_and_b32 v33, v43, v25
    v_and_b32 v34, v43, v26
    v_and_b32 v35, v43, v27
    s_waitcnt vmcnt(8)
    s_nop 0
    v_mfma_f32_16x16x32_bf16 v[16:19], v[32:35], v[76:79], v[16:19]
    v_and_b32 v28, v44, v24
    v_and_b32 v29, v44, v25
    v_and_b32 v30, v44, v26
    v_and_b32 v31, v44, v27
    s_waitcnt vmcnt(7)
    s_nop 0
    v_mfma_f32_16x16x32_bf16 v[16:19], v[28:31], v[80:83], v[16:19]
    v_and_b32 v32, v45, v24
    v_and_b32 v33, v45, v25
    v_and_b32 v34, v45, v26
    v_and_b32 v35, v45, v27
    s_waitcnt vmcnt(6)
    s_nop 0
    v_mfma_f32_16x16x32_bf16 v[16:19], v[32:35], v[84:87], v[16:19]
    v_and_b32 v28, v46, v24
    v_and_b32 v29, v46, v25
    v_and_b32 v30, v46, v26
    v_and_b32 v31, v46, v27
    s_waitcnt vmcnt(5)
    s_nop 0
    v_mfma_f32_16x16x32_bf16 v[16:19], v[28:31], v[88:91], v[16:19]
    v_and_b32 v32, v47, v24
    v_and_b32 v33, v47, v25
    v_and_b32 v34, v47, v26
    v_and_b32 v35, v47, v27
    s_waitcnt vmcnt(4)
    s_nop 0
    v_mfma_f32_16x16x32_bf16 v[16:19], v[32:35], v[92:95], v[16:19]
    v_and_b32 v28, v48, v24
    v_and_b32 v29, v48, v25
    v_and_b32 v30, v48, v26
    v_and_b32 v31, v48, v27
    s_waitcnt vmcnt(3)
    s_nop 0
    v_mfma_f32_16x16x32_bf16 v[16:19], v[28:31], v[96:99], v[16:19]
    v_and_b32 v32, v49, v24
    v_and_b32 v33, v49, v25
    v_and_b32 v34, v49, v26
    v_and_b32 v35, v49, v27
    s_waitcnt vmcnt(2)
    s_nop 0
    v_mfma_f32_16x16x32_bf16 v[16:19], v[32:35], v[100:103], v[16:19]
    v_and_b32 v28, v50, v24
    v_and_b32 v29, v50, v25
    v_and_b32 v30, v50, v26
    v_and_b32 v31, v50, v27
    s_waitcnt vmcnt(1)
    s_nop 0
    v_mfma_f32_16x16x32_bf16 v[16:19], v[28:31], v[104:107], v[16:19]
    v_and_b32 v32, v51, v24
    v_and_b32 v33, v51, v25
    v_and_b32 v34, v51, v26
    v_and_b32 v35, v51, v27
    s_waitcnt vmcnt(0)
    s_nop 0
    v_mfma_f32_16x16x32_bf16 v[16:19], v[32:35], v[108:111], v[16:19]
    s_mov_b32 exec_hi, 0
    s_nop 6
    v_and_or_b32 v16, v16, v23, s65
    v_and_or_b32 v17, v17, v23, s66
    v_and_or_b32 v18, v18, v23, s67
    v_and_or_b32 v19, v19, v23, s68
    buffer_store_dwordx4 v[16:19], v11, s[48:51], s56 offen sc1
    s_branch L_fin
L_hy_y:
    s_cmp_lg_u32 s7, 1
    s_cbranch_scc1 L_neq
L_eqt:
    s_memrealtime s[46:47]
    s_waitcnt lgkmcnt(0)
    s_sub_u32 s46, s46, s69
    s_cmp_ge_i32 s46, 250
    s_cbranch_scc1 L_eqt_d
    s_sleep 4
    s_branch L_eqt
L_eqt_d:
    s_mov_b32 s57, 2
    v_lshlrev_b32 v14, 7, v0
    s_mov_b32 s58, 8192
    buffer_load_dword v12, v14, s[48:51], s58 offen
    s_branch L_eq2
L_eq:
    s_sub_u32 s57, s57, 1
    s_cbranch_scc1 L_neq1
    s_mov_b64 exec, vcc
    s_sleep 16
    buffer_load_dword v12, v14, s[48:51], s58 offen sc1
L_eq2:
    s_waitcnt vmcnt(0)
    v_subrev_u32 v12, s69, v12
    v_add_u32 v13, 256, v12
    v_cmp_lt_u32 vcc, 512, v13
    s_cbranch_vccnz L_eq
    s_mov_b64 exec, -1
    v_add_u32_dpp v12, v12, v12 quad_perm:[1,0,3,2] row_mask:0xf bank_mask:0xf
    s_nop 1
    v_add_u32_dpp v12, v12, v12 quad_perm:[2,3,0,1] row_mask:0xf bank_mask:0xf
    s_nop 1
    v_add_u32_dpp v12, v12, v12 row_half_mirror row_mask:0xf bank_mask:0xf
    s_nop 1
    v_add_u32_dpp v12, v12, v12 row_ror:8 row_mask:0xf bank_mask:0xf
    s_nop 1
    v_add_u32_dpp v12, v12, v12 row_bcast:15 row_mask:0xa bank_mask:0xf
    s_nop 1
    v_add_u32_dpp v12, v12, v12 row_bcast:31 row_mask:0xc bank_mask:0xf
    s_nop 0
    v_readlane_b32 s58, v12, 63
    s_nop 0
    s_ashr_i32 s58, s58, 6
    s_branch L_eq3
L_neq1:
    s_mov_b32 s58, 0
L_eq3:
    s_mov_b64 exec, -1
    v_mov_b32 v13, 0
    v_lshlrev_b32 v14, 2, v0
    s_add_u32 s54, s69, s58
    s_add_u32 s53, s69, 10
    s_sub_u32 s58, s58, 10
    s_mul_i32 s52, s58, 1394
    s_mov_b32 s55, 0
    s_mov_b32 s62, 0
    s_ashr_i32 s58, s55, 16
    s_add_u32 s58, s58, s53
    s_add_u32 s59, s52, s62
    v_mov_b32 v16, s58
    v_mov_b32 v17, s59
    s_mul_i32 s58, s62, 47
    s_add_u32 s58, s58, s55
    s_ashr_i32 s58, s58, 16
    s_add_u32 s58, s58, s54
    ds_write_b64 v13, v[16:17] offset:712
    v_mov_b32 v12, s58
    ds_write_b32 v13, v12 offset:704
    s_bfe_u32 s63, s2, 0x20003
    s_lshl_b32 s63, s63, 7
    s_mul_i32 s69, s62, 14
    s_add_u32 s69, s69, s55
    s_ashr_i32 s69, s69, 16
    s_add_u32 s69, s69, s54
    s_cmp_ge_u32 s2, 64
    s_cbranch_scc1 L_ccr0
L_cc0t0:
    s_memrealtime s[46:47]
    s_waitcnt lgkmcnt(0)
    s_sub_u32 s46, s46, s69
    s_cmp_ge_i32 s46, 520
    s_cbranch_scc1 L_cc0t0_d
    s_sleep 8
    s_branch L_cc0t0
L_cc0t0_d:
    s_mov_b32 s57, 64
L_ccw0:
    ds_read_b32 v12, v13 offset:720
    s_sub_u32 s57, s57, 1
    s_cbranch_scc1 L_ccr0
    s_sleep 2
    s_waitcnt lgkmcnt(0)
    v_readfirstlane_b32 s58, v12
    s_nop 0
    s_sub_u32 s58, s58, 8388608
    s_cbranch_scc1 L_ccw0
    s_min_u32 s58, s58, 18432
    s_bitset1_b32 s58, 24
    v_mov_b32 v12, s58
    s_add_u32 s58, s63, 16384
    s_mov_b64 exec, 1
    buffer_atomic_add v12, v13, s[48:51], s58 offen sc1
    s_mov_b64 exec, -1
L_ccr0:
L_cct0:
    s_memrealtime s[46:47]
    s_waitcnt lgkmcnt(0)
    s_sub_u32 s46, s46, s69
    s_cmp_ge_i32 s46, 710
    s_cbranch_scc1 L_cct0_d
    s_sleep 4
    s_branch L_cct0
L_cct0_d:
    s_load_dword s58, s[48:49], 16384
    s_load_dword s59, s[48:49], 16512
    s_load_dword s46, s[48:49], 16640
    s_load_dword s47, s[48:49], 16768
    s_waitcnt lgkmcnt(0)
    s_add_u32 s58, s58, s59
    s_add_u32 s46, s46, s47
    s_add_u32 s58, s58, s46
    s_lshr_b32 s59, s58, 24
    s_sub_u32 s59, 64, s59
    s_cmp_gt_u32 s59, 32
    s_cbranch_scc1 L_ccx0
    s_and_b32 s58, s58, 0xffffff
    s_mul_i32 s59, s59, 9216
    s_add_u32 s58, s58, s59
    s_sub_i32 s58, s58, 255590
    s_mov_b32 s59, 427
    s_cmp_lt_i32 s58, 0
    s_cselect_b32 s59, 768, s59
    s_mul_i32 s58, s58, s59
    s_ashr_i32 s58, s58, 8
    s_max_i32 s58, s58, -91750
    s_min_i32 s58, s58, 98304
    s_sub_u32 s59, s62, s58
    s_mul_i32 s59, s59, 19
    s_add_u32 s55, s55, s59
    s_mov_b32 s62, s58
    s_ashr_i32 s58, s55, 16
    s_add_u32 s58, s58, s53
    s_add_u32 s59, s52, s62
    v_mov_b32 v16, s58
    v_mov_b32 v17, s59
    s_mul_i32 s58, s62, 47
    s_add_u32 s58, s58, s55
    s_ashr_i32 s58, s58, 16
    s_add_u32 s58, s58, s54
    ds_write_b64 v13, v[16:17] offset:712
    v_mov_b32 v12, s58
    ds_write_b32 v13, v12 offset:704
L_ccx0:
    s_mul_i32 s69, s62, 20
    s_add_u32 s69, s69, s55
    s_ashr_i32 s69, s69, 16
    s_add_u32 s69, s69, s54
    s_cmp_ge_u32 s2, 64
    s_cbranch_scc1 L_ccr1
L_cc0t1:
    s_memrealtime s[46:47]
    s_waitcnt lgkmcnt(0)
    s_sub_u32 s46, s46, s69
    s_cmp_ge_i32 s46, 700
    s_cbranch_scc1 L_cc0t1_d
    s_sleep 8
    s_branch L_cc0t1
L_cc0t1_d:
    s_mov_b32 s57, 64
L_ccw1:
    ds_read_b32 v12, v13 offset:724
    s_sub_u32 s57, s57, 1
    s_cbranch_scc1 L_ccr1
    s_sleep 2
    s_waitcnt lgkmcnt(0)
    v_readfirstlane_b32 s58, v12
    s_nop 0
    s_sub_u32 s58, s58, 8388608
    s_cbranch_scc1 L_ccw1
    s_min_u32 s58, s58, 18432
    s_bitset1_b32 s58, 24
    v_mov_b32 v12, s58
    s_add_u32 s58, s63, 16896
    s_mov_b64 exec, 1
    buffer_atomic_add v12, v13, s[48:51], s58 offen sc1
    s_mov_b64 exec, -1
L_ccr1:
L_cct1:
    s_memrealtime s[46:47]
    s_waitcnt lgkmcnt(0)
    s_sub_u32 s46, s46, s69
    s_cmp_ge_i32 s46, 880
    s_cbranch_scc1 L_cct1_d
    s_sleep 4
    s_branch L_cct1
L_cct1_d:
    s_load_dword s58, s[48:49], 16896
    s_load_dword s59, s[48:49], 17024
    s_load_dword s46, s[48:49], 17152
    s_load_dword s47, s[48:49], 17280
    s_waitcnt lgkmcnt(0)
    s_add_u32 s58, s58, s59
    s_add_u32 s46, s46, s47
    s_add_u32 s58, s58, s46
    s_lshr_b32 s59, s58, 24
    s_sub_u32 s59, 64, s59
    s_cmp_gt_u32 s59, 32
    s_cbranch_scc1 L_ccx1
    s_and_b32 s58, s58, 0xffffff
    s_mul_i32 s59, s59, 9216
    s_add_u32 s58, s58, s59
    s_sub_i32 s58, s58, 221184
    s_mov_b32 s59, 597
    s_cmp_lt_i32 s58, 0
    s_cselect_b32 s59, 1024, s59
    s_mul_i32 s58, s58, s59
    s_ashr_i32 s58, s58, 8
    s_max_i32 s58, s58, -91750
    s_min_i32 s58, s58, 229376
    s_sub_u32 s59, s62, s58
    s_mul_i32 s59, s59, 25
    s_add_u32 s55, s55, s59
    s_mov_b32 s62, s58
    s_ashr_i32 s58, s55, 16
    s_add_u32 s58, s58, s53
    s_add_u32 s59, s52, s62
    v_mov_b32 v16, s58
    v_mov_b32 v17, s59
    s_mul_i32 s58, s62, 47
    s_add_u32 s58, s58, s55
    s_ashr_i32 s58, s58, 16
    s_add_u32 s58, s58, s54
    ds_write_b64 v13, v[16:17] offset:712
    v_mov_b32 v12, s58
    ds_write_b32 v13, v12 offset:704
L_ccx1:
    s_mul_i32 s69, s62, 32
    s_add_u32 s69, s69, s55
    s_ashr_i32 s69, s69, 16
    s_add_u32 s69, s69, s54
    s_cmp_ge_u32 s2, 64
    s_cbranch_scc1 L_ccr2
L_cc0t2:
    s_memrealtime s[46:47]
    s_waitcnt lgkmcnt(0)
    s_sub_u32 s46, s46, s69
    s_cmp_ge_i32 s46, 1060
    s_cbranch_scc1 L_cc0t2_d
    s_sleep 8
    s_branch L_cc0t2
L_cc0t2_d:
    s_mov_b32 s57, 64
L_ccw2:
    ds_read_b32 v12, v13 offset:728
    s_sub_u32 s57, s57, 1
    s_cbranch_scc1 L_ccr2
    s_sleep 2
    s_waitcnt lgkmcnt(0)
    v_readfirstlane_b32 s58, v12
    s_nop 0
    s_sub_u32 s58, s58, 8388608
    s_cbranch_scc1 L_ccw2
    s_min_u32 s58, s58, 18432
    s_bitset1_b32 s58, 24
    v_mov_b32 v12, s58
    s_add_u32 s58, s63, 17408
    s_mov_b64 exec, 1
    buffer_atomic_add v12, v13, s[48:51], s58 offen sc1
    s_mov_b64 exec, -1
L_ccr2:
L_cct2:
    s_memrealtime s[46:47]
    s_waitcnt lgkmcnt(0)
    s_sub_u32 s46, s46, s69
    s_cmp_ge_i32 s46, 1230
    s_cbranch_scc1 L_cct2_d
    s_sleep 4
    s_branch L_cct2
L_cct2_d:
    s_load_dword s58, s[48:49], 17408
    s_load_dword s59, s[48:49], 17536
    s_load_dword s46, s[48:49], 17664
    s_load_dword s47, s[48:49], 17792
    s_waitcnt lgkmcnt(0)
    s_add_u32 s58, s58, s59
    s_add_u32 s46, s46, s47
    s_add_u32 s58, s58, s46
    s_lshr_b32 s59, s58, 24
    s_sub_u32 s59, 64, s59
    s_cmp_gt_u32 s59, 32
    s_cbranch_scc1 L_ccx2
    s_and_b32 s58, s58, 0xffffff
    s_mul_i32 s59, s59, 9216
    s_add_u32 s58, s58, s59
    s_sub_i32 s58, s58, 211353
    s_mov_b32 s59, 597
    s_cmp_lt_i32 s58, 0
    s_cselect_b32 s59, 597, s59
    s_mul_i32 s58, s58, s59
    s_ashr_i32 s58, s58, 8
    s_add_u32 s58, s58, s62
    s_max_i32 s58, s58, -91750
    s_min_i32 s58, s58, 294912
    s_sub_u32 s59, s62, s58
    s_mul_i32 s59, s59, 37
    s_add_u32 s55, s55, s59
    s_mov_b32 s62, s58
    s_ashr_i32 s58, s55, 16
    s_add_u32 s58, s58, s53
    s_add_u32 s59, s52, s62
    v_mov_b32 v16, s58
    v_mov_b32 v17, s59
    s_mul_i32 s58, s62, 47
    s_add_u32 s58, s58, s55
    s_ashr_i32 s58, s58, 16
    s_add_u32 s58, s58, s54
    ds_write_b64 v13, v[16:17] offset:712
    v_mov_b32 v12, s58
    ds_write_b32 v13, v12 offset:704
L_ccx2:
    s_mov_b32 s69, s54
L_neq:
    s_mov_b64 exec, -1
    s_waitcnt vmcnt(0) lgkmcnt(0)
    s_lshl_b32 s59, s5, 1
    s_add_u32 s59, s59, s7
    s_sub_u32 s59, s59, 1
    s_cmp_eq_u32 s59, 15
    s_cbranch_scc1 L_fin
    s_mul_i32 s62, s59, 13
    s_lshr_b32 s62, s62, 6
    s_mul_i32 s63, s62, 5
    s_sub_u32 s63, s59, s63
    s_lshl_b32 s58, s63, 16
    s_add_u32 s56, s56, s58
    s_lshl_b32 s58, s62, 8
    s_add_u32 s56, s56, s58
    v_mul_u32_u24 v6, 1280, v4
    v_lshl_add_u32 v6, v5, 4, v6
    s_mul_i32 s52, s4, 245760
    s_mul_i32 s53, s62, 81920
    s_add_u32 s52, s52, s53
    s_lshl_b32 s53, s63, 8
    s_add_u32 s52, s52, s53
    v_lshlrev_b32 v10, 4, v0
    s_lshl_b32 s55, s4, 13
    s_lshl_b32 s53, s62, 11
    s_add_u32 s55, s55, s53
    s_add_u32 s55, s55, 524288
    s_lshl_b32 s53, s7, 2
    v_mov_b32 v8, s53
    s_lshl_b32 s53, s7, 8
    v_add_u32 v9, s53, v21
L_wot1:
    s_memrealtime s[46:47]
    s_waitcnt lgkmcnt(0)
    s_sub_u32 s46, s46, s69
    s_cmp_ge_i32 s46, 1444
    s_cbranch_scc1 L_wot1_d
    s_sleep 16
    s_branch L_wot1
L_wot1_d:
    v_mov_b32 v13, 0
    ds_read_b32 v12, v13 offset:704
    s_waitcnt lgkmcnt(0)
    v_readfirstlane_b32 s46, v12
    s_nop 0
    s_cmp_lg_u32 s46, 0
    s_cselect_b32 s69, s46, s69
    s_and_b32 s58, s7, 1
    s_lshl_b32 s58, s58, 2
    s_sub_u32 s69, s69, s58
L_wot0:
    s_memrealtime s[46:47]
    s_waitcnt lgkmcnt(0)
    s_sub_u32 s46, s46, s69
    s_cmp_ge_i32 s46, 1614
    s_cbranch_scc1 L_wot0_d
    s_sleep 4
    s_branch L_wot0
L_wot0_d:
L_wot:
    s_memrealtime s[46:47]
    s_waitcnt lgkmcnt(0)
    s_sub_u32 s46, s46, s69
    s_cmp_ge_i32 s46, 1644
    s_cbranch_scc1 L_wot_d
    s_sleep 1
    s_branch L_wot
L_wot_d:
    s_add_u32 s69, s69, 1644
    buffer_load_dwordx4 v[64:67], v6, s[24:27], s52 offen nt
    s_add_u32 s52, s52, 5120
L_wop1:
    s_memrealtime s[46:47]
    s_waitcnt lgkmcnt(0)
    s_sub_u32 s46, s46, s69
    s_cmp_ge_i32 s46, 8
    s_cbranch_scc1 L_wop1_d
    s_sleep 1
    s_branch L_wop1
L_wop1_d:
    buffer_load_dwordx4 v[68:71], v6, s[24:27], s52 offen nt
    s_add_u32 s52, s52, 5120
L_wop2:
    s_memrealtime s[46:47]
    s_waitcnt lgkmcnt(0)
    s_sub_u32 s46, s46, s69
    s_cmp_ge_i32 s46, 16
    s_cbranch_scc1 L_wop2_d
    s_sleep 1
    s_branch L_wop2
L_wop2_d:
    buffer_load_dwordx4 v[72:75], v6, s[24:27], s52 offen nt
    s_add_u32 s52, s52, 5120
L_wop3:
    s_memrealtime s[46:47]
    s_waitcnt lgkmcnt(0)
    s_sub_u32 s46, s46, s69
    s_cmp_ge_i32 s46, 24
    s_cbranch_scc1 L_wop3_d
    s_sleep 1
    s_branch L_wop3
L_wop3_d:
    buffer_load_dwordx4 v[76:79], v6, s[24:27], s52 offen nt
    s_add_u32 s52, s52, 5120
L_wop4:
    s_memrealtime s[46:47]
    s_waitcnt lgkmcnt(0)
    s_sub_u32 s46, s46, s69
    s_cmp_ge_i32 s46, 32
    s_cbranch_scc1 L_wop4_d
    s_sleep 1
    s_branch L_wop4
L_wop4_d:
    buffer_load_dwordx4 v[80:83], v6, s[24:27], s52 offen nt
    s_add_u32 s52, s52, 5120
L_wop5:
    s_memrealtime s[46:47]
    s_waitcnt lgkmcnt(0)
    s_sub_u32 s46, s46, s69
    s_cmp_ge_i32 s46, 40
    s_cbranch_scc1 L_wop5_d
    s_sleep 1
    s_branch L_wop5
L_wop5_d:
    buffer_load_dwordx4 v[84:87], v6, s[24:27], s52 offen nt
    s_add_u32 s52, s52, 5120
L_wop6:
    s_memrealtime s[46:47]
    s_waitcnt lgkmcnt(0)
    s_sub_u32 s46, s46, s69
    s_cmp_ge_i32 s46, 48
    s_cbranch_scc1 L_wop6_d
    s_sleep 1
    s_branch L_wop6
L_wop6_d:
    buffer_load_dwordx4 v[88:91], v6, s[24:27], s52 offen nt
    s_add_u32 s52, s52, 5120
L_wop7:
    s_memrealtime s[46:47]
    s_waitcnt lgkmcnt(0)
    s_sub_u32 s46, s46, s69
    s_cmp_ge_i32 s46, 56
    s_cbranch_scc1 L_wop7_d
    s_sleep 1
    s_branch L_wop7
L_wop7_d:
    buffer_load_dwordx4 v[92:95], v6, s[24:27], s52 offen nt
    s_add_u32 s52, s52, 5120
L_wop8:
    s_memrealtime s[46:47]
    s_waitcnt lgkmcnt(0)
    s_sub_u32 s46, s46, s69
    s_cmp_ge_i32 s46, 64
    s_cbranch_scc1 L_wop8_d
    s_sleep 1
    s_branch L_wop8
L_wop8_d:
    buffer_load_dwordx4 v[96:99], v6, s[24:27], s52 offen nt
    s_add_u32 s52, s52, 5120
L_wop9:
    s_memrealtime s[46:47]
    s_waitcnt lgkmcnt(0)
    s_sub_u32 s46, s46, s69
    s_cmp_ge_i32 s46, 72
    s_cbranch_scc1 L_wop9_d
    s_sleep 1
    s_branch L_wop9
L_wop9_d:
    buffer_load_dwordx4 v[100:103], v6, s[24:27], s52 offen nt
    s_add_u32 s52, s52, 5120
L_wop10:
    s_memrealtime s[46:47]
    s_waitcnt lgkmcnt(0)
    s_sub_u32 s46, s46, s69
    s_cmp_ge_i32 s46, 80
    s_cbranch_scc1 L_wop10_d
    s_sleep 1
    s_branch L_wop10
L_wop10_d:
    buffer_load_dwordx4 v[104:107], v6, s[24:27], s52 offen nt
    s_add_u32 s52, s52, 5120
L_wop11:
    s_memrealtime s[46:47]
    s_waitcnt lgkmcnt(0)
    s_sub_u32 s46, s46, s69
    s_cmp_ge_i32 s46, 88
    s_cbranch_scc1 L_wop11_d
    s_sleep 1
    s_branch L_wop11
L_wop11_d:
    buffer_load_dwordx4 v[108:111], v6, s[24:27], s52 offen nt
    s_add_u32 s52, s52, 5120
L_wop12:
    s_memrealtime s[46:47]
    s_waitcnt lgkmcnt(0)
    s_sub_u32 s46, s46, s69
    s_cmp_ge_i32 s46, 96
    s_cbranch_scc1 L_wop12_d
    s_sleep 1
    s_branch L_wop12
L_wop12_d:
    buffer_load_dwordx4 v[112:115], v6, s[24:27], s52 offen nt
    s_add_u32 s52, s52, 5120
L_wop13:
    s_memrealtime s[46:47]
    s_waitcnt lgkmcnt(0)
    s_sub_u32 s46, s46, s69
    s_cmp_ge_i32 s46, 104
    s_cbranch_scc1 L_wop13_d
    s_sleep 1
    s_branch L_wop13
L_wop13_d:
    buffer_load_dwordx4 v[116:119], v6, s[24:27], s52 offen nt
    s_add_u32 s52, s52, 5120
L_wop14:
    s_memrealtime s[46:47]
    s_waitcnt lgkmcnt(0)
    s_sub_u32 s46, s46, s69
    s_cmp_ge_i32 s46, 112
    s_cbranch_scc1 L_wop14_d
    s_sleep 1
    s_branch L_wop14
L_wop14_d:
    buffer_load_dwordx4 v[120:123], v6, s[24:27], s52 offen nt
    s_add_u32 s52, s52, 5120
L_wop15:
    s_memrealtime s[46:47]
    s_waitcnt lgkmcnt(0)
    s_sub_u32 s46, s46, s69
    s_cmp_ge_i32 s46, 120
    s_cbranch_scc1 L_wop15_d
    s_sleep 1
    s_branch L_wop15
L_wop15_d:
    buffer_load_dwordx4 v[124:127], v6, s[24:27], s52 offen nt
    s_mov_b32 s57, 32768
    buffer_load_dwordx4 v[128:131], v10, s[48:51], s55 offen offset:0 sc1
    buffer_load_dwordx4 v[132:135], v10, s[48:51], s55 offen offset:1024 sc1
L_po:
    s_waitcnt vmcnt(1)
    v_xor_b32 v128, s65, v128
    v_xor_b32 v129, s66, v129
    v_xor_b32 v130, s67, v130
    v_xor_b32 v131, s68, v131
    v_or3_b32 v16, v128, v129, v130
    v_or_b32 v16, v16, v131
    s_waitcnt vmcnt(0)
    v_xor_b32 v132, s65, v132
    v_xor_b32 v133, s66, v133
    v_xor_b32 v134, s67, v134
    v_xor_b32 v135, s68, v135
    v_or3_b32 v16, v16, v132, v133
    v_or3_b32 v16, v16, v134, v135
    v_pk_add_f32 v[12:13], v[128:129], v[132:133]
    v_pk_add_f32 v[14:15], v[130:131], v[134:135]
    v_and_b32 v16, 0xff, v16
    v_cmp_ne_u32 vcc, 0, v16
    s_cbranch_vccz L_po_d0
    buffer_load_dwordx4 v[128:131], v10, s[48:51], s55 offen offset:0 sc1
    buffer_load_dwordx4 v[132:135], v10, s[48:51], s55 offen offset:1024 sc1
    s_sub_u32 s57, s57, 1
    s_cbranch_scc0 L_po
    s_waitcnt vmcnt(0)
L_po_d0:
    s_nop 1
L_po_done:
    s_nop 1
    v_permlane32_swap_b32 v12, v14
    v_permlane32_swap_b32 v13, v15
    v_add_f32 v12, v12, v14
    v_add_f32 v13, v13, v15
    s_nop 1
    v_permlane16_swap_b32 v12, v13
    v_add_f32 v12, v12, v13
    v_cvt_pk_bf16_f32 v12, v12, v12
    s_nop 1
    v_and_b32_dpp v28, v12, v24 row_newbcast:0 row_mask:0xf bank_mask:0xf
    v_and_b32_dpp v29, v12, v25 row_newbcast:0 row_mask:0xf bank_mask:0xf
    v_and_b32_dpp v30, v12, v26 row_newbcast:0 row_mask:0xf bank_mask:0xf
    v_and_b32_dpp v31, v12, v27 row_newbcast:0 row_mask:0xf bank_mask:0xf
    v_and_b32_dpp v32, v12, v24 row_newbcast:1 row_mask:0xf bank_mask:0xf
    v_and_b32_dpp v33, v12, v25 row_newbcast:1 row_mask:0xf bank_mask:0xf
    v_and_b32_dpp v34, v12, v26 row_newbcast:1 row_mask:0xf bank_mask:0xf
    v_and_b32_dpp v35, v12, v27 row_newbcast:1 row_mask:0xf bank_mask:0xf
    v_mfma_f32_16x16x32_bf16 v[16:19], v[28:31], v[64:67], 0
    v_and_b32_dpp v36, v12, v24 row_newbcast:2 row_mask:0xf bank_mask:0xf
    v_and_b32_dpp v37, v12, v25 row_newbcast:2 row_mask:0xf bank_mask:0xf
    v_and_b32_dpp v38, v12, v26 row_newbcast:2 row_mask:0xf bank_mask:0xf
    v_and_b32_dpp v39, v12, v27 row_newbcast:2 row_mask:0xf bank_mask:0xf
    v_mfma_f32_16x16x32_bf16 v[16:19], v[32:35], v[68:71], v[16:19]
    v_and_b32_dpp v28, v12, v24 row_newbcast:3 row_mask:0xf bank_mask:0xf
    v_and_b32_dpp v29, v12, v25 row_newbcast:3 row_mask:0xf bank_mask:0xf
    v_and_b32_dpp v30, v12, v26 row_newbcast:3 row_mask:0xf bank_mask:0xf
    v_and_b32_dpp v31, v12, v27 row_newbcast:3 row_mask:0xf bank_mask:0xf
    v_mfma_f32_16x16x32_bf16 v[16:19], v[36:39], v[72:75], v[16:19]
    v_and_b32_dpp v32, v12, v24 row_newbcast:4 row_mask:0xf bank_mask:0xf
    v_and_b32_dpp v33, v12, v25 row_newbcast:4 row_mask:0xf bank_mask:0xf
    v_and_b32_dpp v34, v12, v26 row_newbcast:4 row_mask:0xf bank_mask:0xf
    v_and_b32_dpp v35, v12, v27 row_newbcast:4 row_mask:0xf bank_mask:0xf
    v_mfma_f32_16x16x32_bf16 v[16:19], v[28:31], v[76:79], v[16:19]
    v_and_b32_dpp v36, v12, v24 row_newbcast:5 row_mask:0xf bank_mask:0xf
    v_and_b32_dpp v37, v12, v25 row_newbcast:5 row_mask:0xf bank_mask:0xf
    v_and_b32_dpp v38, v12, v26 row_newbcast:5 row_mask:0xf bank_mask:0xf
    v_and_b32_dpp v39, v12, v27 row_newbcast:5 row_mask:0xf bank_mask:0xf
    v_mfma_f32_16x16x32_bf16 v[16:19], v[32:35], v[80:83], v[16:19]
    v_and_b32_dpp v28, v12, v24 row_newbcast:6 row_mask:0xf bank_mask:0xf
    v_and_b32_dpp v29, v12, v25 row_newbcast:6 row_mask:0xf bank_mask:0xf
    v_and_b32_dpp v30, v12, v26 row_newbcast:6 row_mask:0xf bank_mask:0xf
    v_and_b32_dpp v31, v12, v27 row_newbcast:6 row_mask:0xf bank_mask:0xf
    v_mfma_f32_16x16x32_bf16 v[16:19], v[36:39], v[84:87], v[16:19]
    v_and_b32_dpp v32, v12, v24 row_newbcast:7 row_mask:0xf bank_mask:0xf
    v_and_b32_dpp v33, v12, v25 row_newbcast:7 row_mask:0xf bank_mask:0xf
    v_and_b32_dpp v34, v12, v26 row_newbcast:7 row_mask:0xf bank_mask:0xf
    v_and_b32_dpp v35, v12, v27 row_newbcast:7 row_mask:0xf bank_mask:0xf
    v_mfma_f32_16x16x32_bf16 v[16:19], v[28:31], v[88:91], v[16:19]
    v_and_b32_dpp v36, v12, v24 row_newbcast:8 row_mask:0xf bank_mask:0xf
    v_and_b32_dpp v37, v12, v25 row_newbcast:8 row_mask:0xf bank_mask:0xf
    v_and_b32_dpp v38, v12, v26 row_newbcast:8 row_mask:0xf bank_mask:0xf
    v_and_b32_dpp v39, v12, v27 row_newbcast:8 row_mask:0xf bank_mask:0xf
    v_mfma_f32_16x16x32_bf16 v[16:19], v[32:35], v[92:95], v[16:19]
    v_and_b32_dpp v28, v12, v24 row_newbcast:9 row_mask:0xf bank_mask:0xf
    v_and_b32_dpp v29, v12, v25 row_newbcast:9 row_mask:0xf bank_mask:0xf
    v_and_b32_dpp v30, v12, v26 row_newbcast:9 row_mask:0xf bank_mask:0xf
    v_and_b32_dpp v31, v12, v27 row_newbcast:9 row_mask:0xf bank_mask:0xf
    v_mfma_f32_16x16x32_bf16 v[16:19], v[36:39], v[96:99], v[16:19]
    v_and_b32_dpp v32, v12, v24 row_newbcast:10 row_mask:0xf bank_mask:0xf
    v_and_b32_dpp v33, v12, v25 row_newbcast:10 row_mask:0xf bank_mask:0xf
    v_and_b32_dpp v34, v12, v26 row_newbcast:10 row_mask:0xf bank_mask:0xf
    v_and_b32_dpp v35, v12, v27 row_newbcast:10 row_mask:0xf bank_mask:0xf
    v_mfma_f32_16x16x32_bf16 v[16:19], v[28:31], v[100:103], v[16:19]
    v_and_b32_dpp v36, v12, v24 row_newbcast:11 row_mask:0xf bank_mask:0xf
    v_and_b32_dpp v37, v12, v25 row_newbcast:11 row_mask:0xf bank_mask:0xf
    v_and_b32_dpp v38, v12, v26 row_newbcast:11 row_mask:0xf bank_mask:0xf
    v_and_b32_dpp v39, v12, v27 row_newbcast:11 row_mask:0xf bank_mask:0xf
    v_mfma_f32_16x16x32_bf16 v[16:19], v[32:35], v[104:107], v[16:19]
    v_and_b32_dpp v28, v12, v24 row_newbcast:12 row_mask:0xf bank_mask:0xf
    v_and_b32_dpp v29, v12, v25 row_newbcast:12 row_mask:0xf bank_mask:0xf
    v_and_b32_dpp v30, v12, v26 row_newbcast:12 row_mask:0xf bank_mask:0xf
    v_and_b32_dpp v31, v12, v27 row_newbcast:12 row_mask:0xf bank_mask:0xf
    v_mfma_f32_16x16x32_bf16 v[16:19], v[36:39], v[108:111], v[16:19]
    v_and_b32_dpp v32, v12, v24 row_newbcast:13 row_mask:0xf bank_mask:0xf
    v_and_b32_dpp v33, v12, v25 row_newbcast:13 row_mask:0xf bank_mask:0xf
    v_and_b32_dpp v34, v12, v26 row_newbcast:13 row_mask:0xf bank_mask:0xf
    v_and_b32_dpp v35, v12, v27 row_newbcast:13 row_mask:0xf bank_mask:0xf
    v_mfma_f32_16x16x32_bf16 v[16:19], v[28:31], v[112:115], v[16:19]
    v_and_b32_dpp v36, v12, v24 row_newbcast:14 row_mask:0xf bank_mask:0xf
    v_and_b32_dpp v37, v12, v25 row_newbcast:14 row_mask:0xf bank_mask:0xf
    v_and_b32_dpp v38, v12, v26 row_newbcast:14 row_mask:0xf bank_mask:0xf
    v_and_b32_dpp v39, v12, v27 row_newbcast:14 row_mask:0xf bank_mask:0xf
    v_mfma_f32_16x16x32_bf16 v[16:19], v[32:35], v[116:119], v[16:19]
    v_and_b32_dpp v28, v12, v24 row_newbcast:15 row_mask:0xf bank_mask:0xf
    v_and_b32_dpp v29, v12, v25 row_newbcast:15 row_mask:0xf bank_mask:0xf
    v_and_b32_dpp v30, v12, v26 row_newbcast:15 row_mask:0xf bank_mask:0xf
    v_and_b32_dpp v31, v12, v27 row_newbcast:15 row_mask:0xf bank_mask:0xf
    v_mfma_f32_16x16x32_bf16 v[16:19], v[36:39], v[120:123], v[16:19]
    s_nop 0
    v_mfma_f32_16x16x32_bf16 v[16:19], v[28:31], v[124:127], v[16:19]
    s_mov_b32 exec_hi, 0
    s_nop 6
    v_and_or_b32 v16, v16, v23, s65
    v_and_or_b32 v17, v17, v23, s66
    v_and_or_b32 v18, v18, v23, s67
    v_and_or_b32 v19, v19, v23, s68
    buffer_store_dwordx4 v[16:19], v11, s[48:51], s56 offen sc1
L_fin:
L_end:
    s_endpgm
L_stream:
    s_mul_i32 s59, s7, 4
    s_mov_b32 s47, s62
    s_mov_b32 s64, s59
    s_add_u32 s62, s62, s59
    s_load_dwordx2 s[16:17], s[0:1], 16
    s_mov_b32 s18, 50331648
    s_mov_b32 s19, 0x20000
    s_getpc_b64 s[44:45]
L_pc:
    s_sub_u32 s44, s44, L_pc-L_start
    s_subb_u32 s45, s45, 0
    s_lshl_b32 s53, s7, 13
    v_lshlrev_b32 v30, 7, v0
    v_add_u32 v30, s53, v30
    v_min_u32 v30, L_last-L_start, v30
    global_load_dword v167, v30, s[44:45]
    s_add_u32 s53, s52, 6144
    s_add_u32 s54, s52, 12288
    s_add_u32 s55, s52, 18432
    v_and_b32 v30, 1, v2
    v_lshlrev_b32 v30, 4, v30
    v_mov_b32 v31, 0xffff
    v_lshlrev_b32 v30, v30, v31
    v_lshrrev_b32 v31, 1, v2
    v_cmp_eq_u32 vcc, 0, v31
    s_nop 1
    v_cndmask_b32 v4, 0, v30, vcc
    v_cmp_eq_u32 vcc, 1, v31
    s_nop 1
    v_cndmask_b32 v5, 0, v30, vcc
    v_cmp_eq_u32 vcc, 2, v31
    s_nop 1
    v_cndmask_b32 v6, 0, v30, vcc
    v_cmp_eq_u32 vcc, 3, v31
    s_nop 1
    v_cndmask_b32 v7, 0, v30, vcc
    v_mov_b32 v8, 0
    v_mov_b32 v9, 0
    v_mov_b32 v10, 0
    v_mov_b32 v11, 0
    v_mov_b32 v12, 0
    v_mov_b32 v13, 0
    v_mov_b32 v14, 0
    v_mov_b32 v15, 0
    v_lshlrev_b32 v28, 4, v2
    s_lshl_b32 s56, s6, 7
    s_lshl_b32 s57, s7, 4
    s_add_u32 s56, s56, s57
    s_add_u32 s56, s56, 458752
    v_lshrrev_b32 v30, 5, v0
    v_mul_u32_u24 v30, 768, v30
    v_lshl_add_u32 v30, v2, 5, v30
    v_and_b32 v31, 16, v0
    v_add_u32 v30, v30, v31
    s_mul_i32 s57, s7, 1536
    v_add_u32 v30, s57, v30
    s_lshl_b32 s57, s5, 5
    s_lshl_b32 s58, s7, 2
    s_add_u32 s57, s57, s58
    v_mov_b32 v31, s57
    v_mov_b32 v32, s58
    v_mov_b32 v33, 1
    s_waitcnt lgkmcnt(0)
L_pc0:
    s_memrealtime s[58:59]
    s_waitcnt lgkmcnt(0)
    s_sub_u32 s58, s58, s62
    s_cmp_ge_i32 s58, 190
    s_cbranch_scc1 L_pd0
    s_sleep 1
    s_branch L_pc0
L_pd0:
    buffer_load_dwordx4 v[36:39], v3, s[12:15], s52 offen offset:0 nt
L_pc1:
    s_memrealtime s[58:59]
    s_waitcnt lgkmcnt(0)
    s_sub_u32 s58, s58, s62
    s_cmp_ge_i32 s58, 220
    s_cbranch_scc1 L_pd1
    s_sleep 1
    s_branch L_pc1
L_pd1:
    buffer_load_dwordx4 v[40:43], v3, s[12:15], s52 offen offset:128 nt
L_pc2:
    s_memrealtime s[58:59]
    s_waitcnt lgkmcnt(0)
    s_sub_u32 s58, s58, s62
    s_cmp_ge_i32 s58, 250
    s_cbranch_scc1 L_pd2
    s_sleep 1
    s_branch L_pc2
L_pd2:
    buffer_load_dwordx4 v[44:47], v3, s[12:15], s52 offen offset:256 nt
    ds_read_b64 v[0:1], v29 offset:712
L_pc3:
    s_memrealtime s[58:59]
    s_waitcnt lgkmcnt(0)
    s_sub_u32 s58, s58, s62
    s_cmp_ge_i32 s58, 280
    s_cbranch_scc1 L_pd3
    s_sleep 1
    s_branch L_pc3
L_pd3:
    buffer_load_dwordx4 v[48:51], v3, s[12:15], s52 offen offset:3072 nt
    v_readfirstlane_b32 s62, v0
    v_readfirstlane_b32 s60, v1
    s_cmp_lg_u32 s62, 0
    s_cselect_b32 s62, s62, s47
    s_add_u32 s62, s62, s64
    s_mul_i32 s63, s60, 4
    s_ashr_i32 s69, s63, 16
    s_add_u32 s69, s69, s62
    ds_read_b64 v[0:1], v29 offset:712
L_pc4:
    s_memrealtime s[58:59]
    s_waitcnt lgkmcnt(0)
    s_sub_u32 s58, s58, s69
    s_cmp_ge_i32 s58, 310
    s_cbranch_scc1 L_pd4
    s_sleep 1
    s_branch L_pc4
L_pd4:
    buffer_load_dwordx4 v[52:55], v3, s[12:15], s52 offen offset:3200 nt
    v_readfirstlane_b32 s62, v0
    v_readfirstlane_b32 s60, v1
    s_cmp_lg_u32 s62, 0
    s_cselect_b32 s62, s62, s47
    s_add_u32 s62, s62, s64
    s_mul_i32 s63, s60, 5
    s_ashr_i32 s69, s63, 16
    s_add_u32 s69, s69, s62
    ds_read_b64 v[0:1], v29 offset:712
L_pc5:
    s_memrealtime s[58:59]
    s_waitcnt lgkmcnt(0)
    s_sub_u32 s58, s58, s69
    s_cmp_ge_i32 s58, 340
    s_cbranch_scc1 L_pd5
    s_sleep 1
    s_branch L_pc5
L_pd5:
    buffer_load_dwordx4 v[56:59], v3, s[12:15], s52 offen offset:3328 nt
    v_readfirstlane_b32 s62, v0
    v_readfirstlane_b32 s60, v1
    s_cmp_lg_u32 s62, 0
    s_cselect_b32 s62, s62, s47
    s_add_u32 s62, s62, s64
    s_mul_i32 s63, s60, 6
    s_ashr_i32 s69, s63, 16
    s_add_u32 s69, s69, s62
    ds_read_b64 v[0:1], v29 offset:712
L_pc6:
    s_memrealtime s[58:59]
    s_waitcnt lgkmcnt(0)
    s_sub_u32 s58, s58, s69
    s_cmp_ge_i32 s58, 370
    s_cbranch_scc1 L_pd6
    s_sleep 1
    s_branch L_pc6
L_pd6:
    buffer_load_dwordx4 v[60:63], v3, s[12:15], s53 offen offset:0 nt
    v_readfirstlane_b32 s62, v0
    v_readfirstlane_b32 s60, v1
    s_cmp_lg_u32 s62, 0
    s_cselect_b32 s62, s62, s47
    s_add_u32 s62, s62, s64
    s_mul_i32 s63, s60, 7
    s_ashr_i32 s69, s63, 16
    s_add_u32 s69, s69, s62
    ds_read_b64 v[0:1], v29 offset:712
L_pc7:
    s_memrealtime s[58:59]
    s_waitcnt lgkmcnt(0)
    s_sub_u32 s58, s58, s69
    s_cmp_ge_i32 s58, 400
    s_cbranch_scc1 L_pd7
    s_sleep 1
    s_branch L_pc7
L_pd7:
    buffer_load_dwordx4 v[64:67], v3, s[12:15], s53 offen offset:128 nt
    v_readfirstlane_b32 s62, v0
    v_readfirstlane_b32 s60, v1
    s_cmp_lg_u32 s62, 0
    s_cselect_b32 s62, s62, s47
    s_add_u32 s62, s62, s64
    s_mul_i32 s63, s60, 8
    s_ashr_i32 s69, s63, 16
    s_add_u32 s69, s69, s62
    ds_read_b64 v[0:1], v29 offset:712
L_pc8:
    s_memrealtime s[58:59]
    s_waitcnt lgkmcnt(0)
    s_sub_u32 s58, s58, s69
    s_cmp_ge_i32 s58, 430
    s_cbranch_scc1 L_pd8
    s_sleep 1
    s_branch L_pc8
L_pd8:
    s_getreg_b32 s59, hwreg(7, 0, 4)
    s_sub_u32 s46, s58, -1045546
    s_lshl_b32 s59, s59, 5
    s_add_u32 s46, s46, s59
    buffer_load_dwordx4 v[68:71], v3, s[12:15], s53 offen offset:256 nt
    v_readfirstlane_b32 s62, v0
    v_readfirstlane_b32 s60, v1
    s_cmp_lg_u32 s62, 0
    s_cselect_b32 s62, s62, s47
    s_add_u32 s62, s62, s64
    s_mul_i32 s63, s60, 9
    s_ashr_i32 s69, s63, 16
    s_add_u32 s69, s69, s62
    ds_read_b64 v[0:1], v29 offset:712
L_pc9:
    s_memrealtime s[58:59]
    s_waitcnt lgkmcnt(0)
    s_sub_u32 s58, s58, s69
    s_cmp_ge_i32 s58, 460
    s_cbranch_scc1 L_pd9
    s_sleep 1
    s_branch L_pc9
L_pd9:
    s_getreg_b32 s59, hwreg(7, 0, 4)
    s_add_u32 s46, s46, s58
    s_lshl_b32 s59, s59, 5
    s_add_u32 s46, s46, s59
    buffer_load_dwordx4 v[72:75], v3, s[12:15], s53 offen offset:3072 nt
    v_readfirstlane_b32 s62, v0
    v_readfirstlane_b32 s60, v1
    s_cmp_lg_u32 s62, 0
    s_cselect_b32 s62, s62, s47
    s_add_u32 s62, s62, s64
    s_mul_i32 s63, s60, 10
    s_ashr_i32 s69, s63, 16
    s_add_u32 s69, s69, s62
    ds_read_b64 v[0:1], v29 offset:712
L_pc10:
    s_memrealtime s[58:59]
    s_waitcnt lgkmcnt(0)
    s_sub_u32 s58, s58, s69
    s_cmp_ge_i32 s58, 490
    s_cbranch_scc1 L_pd10
    s_sleep 1
    s_branch L_pc10
L_pd10:
    s_getreg_b32 s59, hwreg(7, 0, 4)
    s_add_u32 s46, s46, s58
    s_lshl_b32 s59, s59, 5
    s_add_u32 s46, s46, s59
    buffer_load_dwordx4 v[76:79], v3, s[12:15], s53 offen offset:3200 nt
    v_readfirstlane_b32 s62, v0
    v_readfirstlane_b32 s60, v1
    s_cmp_lg_u32 s62, 0
    s_cselect_b32 s62, s62, s47
    s_add_u32 s62, s62, s64
    s_mul_i32 s63, s60, 11
    s_ashr_i32 s69, s63, 16
    s_add_u32 s69, s69, s62
    ds_read_b64 v[0:1], v29 offset:712
L_pc11:
    s_memrealtime s[58:59]
    s_waitcnt lgkmcnt(0)
    s_sub_u32 s58, s58, s69
    s_cmp_ge_i32 s58, 520
    s_cbranch_scc1 L_pd11
    s_sleep 1
    s_branch L_pc11
L_pd11:
    s_getreg_b32 s59, hwreg(7, 0, 4)
    s_add_u32 s46, s46, s58
    s_lshl_b32 s59, s59, 5
    s_add_u32 s46, s46, s59
    buffer_load_dwordx4 v[80:83], v3, s[12:15], s53 offen offset:3328 nt
    v_readfirstlane_b32 s62, v0
    v_readfirstlane_b32 s60, v1
    s_cmp_lg_u32 s62, 0
    s_cselect_b32 s62, s62, s47
    s_add_u32 s62, s62, s64
    s_mul_i32 s63, s60, 12
    s_ashr_i32 s69, s63, 16
    s_add_u32 s69, s69, s62
    ds_read_b64 v[0:1], v29 offset:712
L_pc12:
    s_memrealtime s[58:59]
    s_waitcnt lgkmcnt(0)
    s_sub_u32 s58, s58, s69
    s_cmp_ge_i32 s58, 550
    s_cbranch_scc1 L_pd12
    s_sleep 1
    s_branch L_pc12
L_pd12:
    s_getreg_b32 s59, hwreg(7, 0, 4)
    s_add_u32 s46, s46, s58
    s_lshl_b32 s59, s59, 5
    s_add_u32 s46, s46, s59
    buffer_load_dwordx4 v[84:87], v3, s[12:15], s54 offen offset:0 nt
    v_readfirstlane_b32 s62, v0
    v_readfirstlane_b32 s60, v1
    s_cmp_lg_u32 s62, 0
    s_cselect_b32 s62, s62, s47
    s_add_u32 s62, s62, s64
    s_mul_i32 s63, s60, 13
    s_ashr_i32 s69, s63, 16
    s_add_u32 s69, s69, s62
    ds_read_b64 v[0:1], v29 offset:712
L_pc13:
    s_memrealtime s[58:59]
    s_waitcnt lgkmcnt(0)
    s_sub_u32 s58, s58, s69
    s_cmp_ge_i32 s58, 580
    s_cbranch_scc1 L_pd13
    s_sleep 1
    s_branch L_pc13
L_pd13:
    s_getreg_b32 s59, hwreg(7, 0, 4)
    s_add_u32 s46, s46, s58
    s_lshl_b32 s59, s59, 5
    s_add_u32 s46, s46, s59
    buffer_load_dwordx4 v[88:91], v3, s[12:15], s54 offen offset:128 nt
    s_min_u32 s46, s46, 1179647
    v_mov_b32 v34, s46
    s_mov_b64 exec, 1
    ds_add_u32 v29, v34 offset:720
    s_mov_b64 exec, -1
    v_readfirstlane_b32 s62, v0
    v_readfirstlane_b32 s60, v1
    s_cmp_lg_u32 s62, 0
    s_cselect_b32 s62, s62, s47
    s_add_u32 s62, s62, s64
    s_mul_i32 s63, s60, 14
    s_ashr_i32 s69, s63, 16
    s_add_u32 s69, s69, s62
    ds_read_b64 v[0:1], v29 offset:712
L_pc14:
    s_memrealtime s[58:59]
    s_waitcnt lgkmcnt(0)
    s_sub_u32 s58, s58, s69
    s_cmp_ge_i32 s58, 610
    s_cbranch_scc1 L_pd14
    s_sleep 1
    s_branch L_pc14
L_pd14:
    s_getreg_b32 s59, hwreg(7, 0, 4)
    s_sub_u32 s46, s58, -1044466
    s_lshl_b32 s59, s59, 5
    s_add_u32 s46, s46, s59
    buffer_load_dwordx4 v[92:95], v3, s[12:15], s54 offen offset:256 nt
    v_readfirstlane_b32 s62, v0
    v_readfirstlane_b32 s60, v1
    s_cmp_lg_u32 s62, 0
    s_cselect_b32 s62, s62, s47
    s_add_u32 s62, s62, s64
    s_mul_i32 s63, s60, 15
    s_ashr_i32 s69, s63, 16
    s_add_u32 s69, s69, s62
    ds_read_b64 v[0:1], v29 offset:712
L_pc15:
    s_memrealtime s[58:59]
    s_waitcnt lgkmcnt(0)
    s_sub_u32 s58, s58, s69
    s_cmp_ge_i32 s58, 640
    s_cbranch_scc1 L_pd15
    s_sleep 1
    s_branch L_pc15
L_pd15:
    s_getreg_b32 s59, hwreg(7, 0, 4)
    s_add_u32 s46, s46, s58
    s_lshl_b32 s59, s59, 5
    s_add_u32 s46, s46, s59
    buffer_load_dwordx4 v[96:99], v3, s[12:15], s54 offen offset:3072 nt
    v_readfirstlane_b32 s62, v0
    v_readfirstlane_b32 s60, v1
    s_cmp_lg_u32 s62, 0
    s_cselect_b32 s62, s62, s47
    s_add_u32 s62, s62, s64
    s_mul_i32 s63, s60, 16
    s_ashr_i32 s69, s63, 16
    s_add_u32 s69, s69, s62
    ds_read_b64 v[0:1], v29 offset:712
L_pc16:
    s_memrealtime s[58:59]
    s_waitcnt lgkmcnt(0)
    s_sub_u32 s58, s58, s69
    s_cmp_ge_i32 s58, 670
    s_cbranch_scc1 L_pd16
    s_sleep 1
    s_branch L_pc16
L_pd16:
    s_getreg_b32 s59, hwreg(7, 0, 4)
    s_add_u32 s46, s46, s58
    s_lshl_b32 s59, s59, 5
    s_add_u32 s46, s46, s59
    buffer_load_dwordx4 v[100:103], v3, s[12:15], s54 offen offset:3200 nt
    v_readfirstlane_b32 s62, v0
    v_readfirstlane_b32 s60, v1
    s_cmp_lg_u32 s62, 0
    s_cselect_b32 s62, s62, s47
    s_add_u32 s62, s62, s64
    s_mul_i32 s63, s60, 17
    s_ashr_i32 s69, s63, 16
    s_add_u32 s69, s69, s62
    ds_read_b64 v[0:1], v29 offset:712
L_pc17:
    s_memrealtime s[58:59]
    s_waitcnt lgkmcnt(0)
    s_sub_u32 s58, s58, s69
    s_cmp_ge_i32 s58, 700
    s_cbranch_scc1 L_pd17
    s_sleep 1
    s_branch L_pc17
L_pd17:
    s_getreg_b32 s59, hwreg(7, 0, 4)
    s_add_u32 s46, s46, s58
    s_lshl_b32 s59, s59, 5
    s_add_u32 s46, s46, s59
    buffer_load_dwordx4 v[104:107], v3, s[12:15], s54 offen offset:3328 nt
    v_readfirstlane_b32 s62, v0
    v_readfirstlane_b32 s60, v1
    s_cmp_lg_u32 s62, 0
    s_cselect_b32 s62, s62, s47
    s_add_u32 s62, s62, s64
    s_mul_i32 s63, s60, 18
    s_ashr_i32 s69, s63, 16
    s_add_u32 s69, s69, s62
    ds_read_b64 v[0:1], v29 offset:712
L_pc18:
    s_memrealtime s[58:59]
    s_waitcnt lgkmcnt(0)
    s_sub_u32 s58, s58, s69
    s_cmp_ge_i32 s58, 730
    s_cbranch_scc1 L_pd18
    s_sleep 1
    s_branch L_pc18
L_pd18:
    s_getreg_b32 s59, hwreg(7, 0, 4)
    s_add_u32 s46, s46, s58
    s_lshl_b32 s59, s59, 5
    s_add_u32 s46, s46, s59
    buffer_load_dwordx4 v[108:111], v3, s[12:15], s55 offen offset:0 nt
    v_readfirstlane_b32 s62, v0
    v_readfirstlane_b32 s60, v1
    s_cmp_lg_u32 s62, 0
    s_cselect_b32 s62, s62, s47
    s_add_u32 s62, s62, s64
    s_mul_i32 s63, s60, 19
    s_ashr_i32 s69, s63, 16
    s_add_u32 s69, s69, s62
    ds_read_b64 v[0:1], v29 offset:712
L_pc19:
    s_memrealtime s[58:59]
    s_waitcnt lgkmcnt(0)
    s_sub_u32 s58, s58, s69
    s_cmp_ge_i32 s58, 760
    s_cbranch_scc1 L_pd19
    s_sleep 1
    s_branch L_pc19
L_pd19:
    s_getreg_b32 s59, hwreg(7, 0, 4)
    s_add_u32 s46, s46, s58
    s_lshl_b32 s59, s59, 5
    s_add_u32 s46, s46, s59
    buffer_load_dwordx4 v[112:115], v3, s[12:15], s55 offen offset:128 nt
    s_min_u32 s46, s46, 1179647
    v_mov_b32 v34, s46
    s_mov_b64 exec, 1
    ds_add_u32 v29, v34 offset:724
    s_mov_b64 exec, -1
    v_readfirstlane_b32 s62, v0
    v_readfirstlane_b32 s60, v1
    s_cmp_lg_u32 s62, 0
    s_cselect_b32 s62, s62, s47
    s_add_u32 s62, s62, s64
    s_mul_i32 s63, s60, 20
    s_ashr_i32 s69, s63, 16
    s_add_u32 s69, s69, s62
    ds_read_b64 v[0:1], v29 offset:712
L_pc20:
    s_memrealtime s[58:59]
    s_waitcnt lgkmcnt(0)
    s_sub_u32 s58, s58, s69
    s_cmp_ge_i32 s58, 790
    s_cbranch_scc1 L_pd20
    s_sleep 1
    s_branch L_pc20
L_pd20:
    buffer_load_dwordx4 v[116:119], v3, s[12:15], s55 offen offset:256 nt
    v_readfirstlane_b32 s62, v0
    v_readfirstlane_b32 s60, v1
    s_cmp_lg_u32 s62, 0
    s_cselect_b32 s62, s62, s47
    s_add_u32 s62, s62, s64
    s_mul_i32 s63, s60, 21
    s_ashr_i32 s69, s63, 16
    s_add_u32 s69, s69, s62
    ds_read_b64 v[0:1], v29 offset:712
L_pc21:
    s_memrealtime s[58:59]
    s_waitcnt lgkmcnt(0)
    s_sub_u32 s58, s58, s69
    s_cmp_ge_i32 s58, 820
    s_cbranch_scc1 L_pd21
    s_sleep 1
    s_branch L_pc21
L_pd21:
    buffer_load_dwordx4 v[120:123], v3, s[12:15], s55 offen offset:3072 nt
    v_readfirstlane_b32 s62, v0
    v_readfirstlane_b32 s60, v1
    s_cmp_lg_u32 s62, 0
    s_cselect_b32 s62, s62, s47
    s_add_u32 s62, s62, s64
    s_mul_i32 s63, s60, 22
    s_ashr_i32 s69, s63, 16
    s_add_u32 s69, s69, s62
    ds_read_b64 v[0:1], v29 offset:712
L_pc22:
    s_memrealtime s[58:59]
    s_waitcnt lgkmcnt(0)
    s_sub_u32 s58, s58, s69
    s_cmp_ge_i32 s58, 850
    s_cbranch_scc1 L_pd22
    s_sleep 1
    s_branch L_pc22
L_pd22:
    buffer_load_dwordx4 v[124:127], v3, s[12:15], s55 offen offset:3200 nt
    v_readfirstlane_b32 s62, v0
    v_readfirstlane_b32 s60, v1
    s_cmp_lg_u32 s62, 0
    s_cselect_b32 s62, s62, s47
    s_add_u32 s62, s62, s64
    s_mul_i32 s63, s60, 23
    s_ashr_i32 s69, s63, 16
    s_add_u32 s69, s69, s62
    ds_read_b64 v[0:1], v29 offset:712
L_pc23:
    s_memrealtime s[58:59]
    s_waitcnt lgkmcnt(0)
    s_sub_u32 s58, s58, s69
    s_cmp_ge_i32 s58, 880
    s_cbranch_scc1 L_pd23
    s_sleep 1
    s_branch L_pc23
L_pd23:
    buffer_load_dwordx4 v[128:131], v3, s[12:15], s55 offen offset:3328 nt
    s_setprio 1
    s_mov_b32 s57, 262144
L_sq:
    ds_read_b64 v[34:35], v29 offset:528
    ds_read_b128 v[16:19], v28 offset:0
    ds_read_b128 v[20:23], v28 offset:128
    ds_read_b128 v[24:27], v28 offset:256
    s_sub_u32 s57, s57, 1
    s_cbranch_scc1 L_sq_done
    s_waitcnt lgkmcnt(0)
    v_cmp_eq_u32 vcc, 0, v34
    s_cbranch_vccz L_sq_done
    s_sleep 2
    s_branch L_sq
L_sq_done:
    s_waitcnt lgkmcnt(0)
    s_waitcnt vmcnt(21)
    v_dot2c_f32_bf16 v8, v36, v16
    v_dot2c_f32_bf16 v8, v37, v17
    v_dot2c_f32_bf16 v8, v38, v18
    v_dot2c_f32_bf16 v8, v39, v19
    v_dot2c_f32_bf16 v8, v40, v20
    v_dot2c_f32_bf16 v8, v41, v21
    v_dot2c_f32_bf16 v8, v42, v22
    v_dot2c_f32_bf16 v8, v43, v23
    v_dot2c_f32_bf16 v8, v44, v24
    v_dot2c_f32_bf16 v8, v45, v25
    v_dot2c_f32_bf16 v8, v46, v26
    v_dot2c_f32_bf16 v8, v47, v27
    v_readfirstlane_b32 s62, v0
    v_readfirstlane_b32 s60, v1
    s_cmp_lg_u32 s62, 0
    s_cselect_b32 s62, s62, s47
    s_add_u32 s62, s62, s64
    s_mul_i32 s63, s60, 24
    s_ashr_i32 s69, s63, 16
    s_add_u32 s69, s69, s62
    ds_read_b64 v[0:1], v29 offset:712
L_pc24:
    s_memrealtime s[58:59]
    s_waitcnt lgkmcnt(0)
    s_sub_u32 s58, s58, s69
    s_cmp_ge_i32 s58, 910
    s_cbranch_scc1 L_pd24
    s_sleep 1
    s_branch L_pc24
L_pd24:
    buffer_load_dwordx4 v[132:135], v3, s[16:19], s52 offen offset:0 nt
    s_waitcnt vmcnt(19)
    v_dot2c_f32_bf16 v9, v48, v16
    v_dot2c_f32_bf16 v9, v49, v17
    v_dot2c_f32_bf16 v9, v50, v18
    v_dot2c_f32_bf16 v9, v51, v19
    v_add_f32_dpp v8, v8, v8 quad_perm:[1,0,3,2] row_mask:0xf bank_mask:0xf
    v_dot2c_f32_bf16 v9, v52, v20
    v_dot2c_f32_bf16 v9, v53, v21
    v_dot2c_f32_bf16 v9, v54, v22
    v_dot2c_f32_bf16 v9, v55, v23
    v_add_f32_dpp v8, v8, v8 quad_perm:[2,3,0,1] row_mask:0xf bank_mask:0xf
    v_dot2c_f32_bf16 v9, v56, v24
    v_dot2c_f32_bf16 v9, v57, v25
    v_dot2c_f32_bf16 v9, v58, v26
    v_dot2c_f32_bf16 v9, v59, v27
    v_add_f32_dpp v8, v8, v8 row_half_mirror row_mask:0xf bank_mask:0xf
    v_readfirstlane_b32 s62, v0
    v_readfirstlane_b32 s60, v1
    s_cmp_lg_u32 s62, 0
    s_cselect_b32 s62, s62, s47
    s_add_u32 s62, s62, s64
    s_mul_i32 s63, s60, 25
    s_ashr_i32 s69, s63, 16
    s_add_u32 s69, s69, s62
    ds_read_b64 v[0:1], v29 offset:712
L_pc25:
    s_memrealtime s[58:59]
    s_waitcnt lgkmcnt(0)
    s_sub_u32 s58, s58, s69
    s_cmp_ge_i32 s58, 940
    s_cbranch_scc1 L_pd25
    s_sleep 1
    s_branch L_pc25
L_pd25:
    buffer_load_dwordx4 v[136:139], v3, s[16:19], s52 offen offset:128 nt
    s_waitcnt vmcnt(17)
    v_dot2c_f32_bf16 v10, v60, v16
    v_dot2c_f32_bf16 v10, v61, v17
    v_dot2c_f32_bf16 v10, v62, v18
    v_dot2c_f32_bf16 v10, v63, v19
    v_add_f32_dpp v9, v9, v9 quad_perm:[1,0,3,2] row_mask:0xf bank_mask:0xf
    v_dot2c_f32_bf16 v10, v64, v20
    v_dot2c_f32_bf16 v10, v65, v21
    v_dot2c_f32_bf16 v10, v66, v22
    v_dot2c_f32_bf16 v10, v67, v23
    v_add_f32_dpp v9, v9, v9 quad_perm:[2,3,0,1] row_mask:0xf bank_mask:0xf
    v_dot2c_f32_bf16 v10, v68, v24
    v_dot2c_f32_bf16 v10, v69, v25
    v_dot2c_f32_bf16 v10, v70, v26
    v_dot2c_f32_bf16 v10, v71, v27
    v_add_f32_dpp v9, v9, v9 row_half_mirror row_mask:0xf bank_mask:0xf
    v_readfirstlane_b32 s62, v0
    v_readfirstlane_b32 s60, v1
    s_cmp_lg_u32 s62, 0
    s_cselect_b32 s62, s62, s47
    s_add_u32 s62, s62, s64
    s_mul_i32 s63, s60, 26
    s_ashr_i32 s69, s63, 16
    s_add_u32 s69, s69, s62
    ds_read_b64 v[0:1], v29 offset:712
L_pc26:
    s_memrealtime s[58:59]
    s_waitcnt lgkmcnt(0)
    s_sub_u32 s58, s58, s69
    s_cmp_ge_i32 s58, 970
    s_cbranch_scc1 L_pd26
    s_sleep 1
    s_branch L_pc26
L_pd26:
    s_getreg_b32 s59, hwreg(7, 0, 4)
    s_sub_u32 s46, s58, -1042306
    s_lshl_b32 s59, s59, 5
    s_add_u32 s46, s46, s59
    buffer_load_dwordx4 v[140:143], v3, s[16:19], s52 offen offset:256 nt
    s_waitcnt vmcnt(15)
    v_dot2c_f32_bf16 v11, v72, v16
    v_dot2c_f32_bf16 v11, v73, v17
    v_dot2c_f32_bf16 v11, v74, v18
    v_dot2c_f32_bf16 v11, v75, v19
    v_add_f32_dpp v10, v10, v10 quad_perm:[1,0,3,2] row_mask:0xf bank_mask:0xf
    v_dot2c_f32_bf16 v11, v76, v20
    v_dot2c_f32_bf16 v11, v77, v21
    v_dot2c_f32_bf16 v11, v78, v22
    v_dot2c_f32_bf16 v11, v79, v23
    v_add_f32_dpp v10, v10, v10 quad_perm:[2,3,0,1] row_mask:0xf bank_mask:0xf
    v_dot2c_f32_bf16 v11, v80, v24
    v_dot2c_f32_bf16 v11, v81, v25
    v_dot2c_f32_bf16 v11, v82, v26
    v_dot2c_f32_bf16 v11, v83, v27
    v_add_f32_dpp v10, v10, v10 row_half_mirror row_mask:0xf bank_mask:0xf
    v_readfirstlane_b32 s62, v0
    v_readfirstlane_b32 s60, v1
    s_cmp_lg_u32 s62, 0
    s_cselect_b32 s62, s62, s47
    s_add_u32 s62, s62, s64
    s_mul_i32 s63, s60, 27
    s_ashr_i32 s69, s63, 16
    s_add_u32 s69, s69, s62
    ds_read_b64 v[0:1], v29 offset:712
L_pc27:
    s_memrealtime s[58:59]
    s_waitcnt lgkmcnt(0)
    s_sub_u32 s58, s58, s69
    s_cmp_ge_i32 s58, 1000
    s_cbranch_scc1 L_pd27
    s_sleep 1
    s_branch L_pc27
L_pd27:
    s_getreg_b32 s59, hwreg(7, 0, 4)
    s_add_u32 s46, s46, s58
    s_lshl_b32 s59, s59, 5
    s_add_u32 s46, s46, s59
    buffer_load_dwordx4 v[144:147], v3, s[16:19], s52 offen offset:3072 nt
    s_waitcnt vmcnt(13)
    v_dot2c_f32_bf16 v12, v84, v16
    v_dot2c_f32_bf16 v12, v85, v17
    v_dot2c_f32_bf16 v12, v86, v18
    v_dot2c_f32_bf16 v12, v87, v19
    v_add_f32_dpp v11, v11, v11 quad_perm:[1,0,3,2] row_mask:0xf bank_mask:0xf
    v_dot2c_f32_bf16 v12, v88, v20
    v_dot2c_f32_bf16 v12, v89, v21
    v_dot2c_f32_bf16 v12, v90, v22
    v_dot2c_f32_bf16 v12, v91, v23
    v_add_f32_dpp v11, v11, v11 quad_perm:[2,3,0,1] row_mask:0xf bank_mask:0xf
    v_dot2c_f32_bf16 v12, v92, v24
    v_dot2c_f32_bf16 v12, v93, v25
    v_dot2c_f32_bf16 v12, v94, v26
    v_dot2c_f32_bf16 v12, v95, v27
    v_add_f32_dpp v11, v11, v11 row_half_mirror row_mask:0xf bank_mask:0xf
    v_readfirstlane_b32 s62, v0
    v_readfirstlane_b32 s60, v1
    s_cmp_lg_u32 s62, 0
    s_cselect_b32 s62, s62, s47
    s_add_u32 s62, s62, s64
    s_mul_i32 s63, s60, 28
    s_ashr_i32 s69, s63, 16
    s_add_u32 s69, s69, s62
    ds_read_b64 v[0:1], v29 offset:712
L_pc28:
    s_memrealtime s[58:59]
    s_waitcnt lgkmcnt(0)
    s_sub_u32 s58, s58, s69
    s_cmp_ge_i32 s58, 1030
    s_cbranch_scc1 L_pd28
    s_sleep 1
    s_branch L_pc28
L_pd28:
    s_getreg_b32 s59, hwreg(7, 0, 4)
    s_add_u32 s46, s46, s58
    s_lshl_b32 s59, s59, 5
    s_add_u32 s46, s46, s59
    buffer_load_dwordx4 v[148:151], v3, s[16:19], s52 offen offset:3200 nt
    s_waitcnt vmcnt(11)
    v_dot2c_f32_bf16 v13, v96, v16
    v_dot2c_f32_bf16 v13, v97, v17
    v_dot2c_f32_bf16 v13, v98, v18
    v_dot2c_f32_bf16 v13, v99, v19
    v_add_f32_dpp v12, v12, v12 quad_perm:[1,0,3,2] row_mask:0xf bank_mask:0xf
    v_dot2c_f32_bf16 v13, v100, v20
    v_dot2c_f32_bf16 v13, v101, v21
    v_dot2c_f32_bf16 v13, v102, v22
    v_dot2c_f32_bf16 v13, v103, v23
    v_add_f32_dpp v12, v12, v12 quad_perm:[2,3,0,1] row_mask:0xf bank_mask:0xf
    v_dot2c_f32_bf16 v13, v104, v24
    v_dot2c_f32_bf16 v13, v105, v25
    v_dot2c_f32_bf16 v13, v106, v26
    v_dot2c_f32_bf16 v13, v107, v27
    v_add_f32_dpp v12, v12, v12 row_half_mirror row_mask:0xf bank_mask:0xf
    v_readfirstlane_b32 s62, v0
    v_readfirstlane_b32 s60, v1
    s_cmp_lg_u32 s62, 0
    s_cselect_b32 s62, s62, s47
    s_add_u32 s62, s62, s64
    s_mul_i32 s63, s60, 29
    s_ashr_i32 s69, s63, 16
    s_add_u32 s69, s69, s62
    ds_read_b64 v[0:1], v29 offset:712
L_pc29:
    s_memrealtime s[58:59]
    s_waitcnt lgkmcnt(0)
    s_sub_u32 s58, s58, s69
    s_cmp_ge_i32 s58, 1060
    s_cbranch_scc1 L_pd29
    s_sleep 1
    s_branch L_pc29
L_pd29:
    s_getreg_b32 s59, hwreg(7, 0, 4)
    s_add_u32 s46, s46, s58
    s_lshl_b32 s59, s59, 5
    s_add_u32 s46, s46, s59
    buffer_load_dwordx4 v[152:155], v3, s[16:19], s52 offen offset:3328 nt
    s_waitcnt vmcnt(9)
    v_dot2c_f32_bf16 v14, v108, v16
    v_dot2c_f32_bf16 v14, v109, v17
    v_dot2c_f32_bf16 v14, v110, v18
    v_dot2c_f32_bf16 v14, v111, v19
    v_add_f32_dpp v13, v13, v13 quad_perm:[1,0,3,2] row_mask:0xf bank_mask:0xf
    v_dot2c_f32_bf16 v14, v112, v20
    v_dot2c_f32_bf16 v14, v113, v21
    v_dot2c_f32_bf16 v14, v114, v22
    v_dot2c_f32_bf16 v14, v115, v23
    v_add_f32_dpp v13, v13, v13 quad_perm:[2,3,0,1] row_mask:0xf bank_mask:0xf
    v_dot2c_f32_bf16 v14, v116, v24
    v_dot2c_f32_bf16 v14, v117, v25
    v_dot2c_f32_bf16 v14, v118, v26
    v_dot2c_f32_bf16 v14, v119, v27
    v_add_f32_dpp v13, v13, v13 row_half_mirror row_mask:0xf bank_mask:0xf
    v_readfirstlane_b32 s62, v0
    v_readfirstlane_b32 s60, v1
    s_cmp_lg_u32 s62, 0
    s_cselect_b32 s62, s62, s47
    s_add_u32 s62, s62, s64
    s_mul_i32 s63, s60, 30
    s_ashr_i32 s69, s63, 16
    s_add_u32 s69, s69, s62
    ds_read_b64 v[0:1], v29 offset:712
L_pc30:
    s_memrealtime s[58:59]
    s_waitcnt lgkmcnt(0)
    s_sub_u32 s58, s58, s69
    s_cmp_ge_i32 s58, 1090
    s_cbranch_scc1 L_pd30
    s_sleep 1
    s_branch L_pc30
L_pd30:
    s_getreg_b32 s59, hwreg(7, 0, 4)
    s_add_u32 s46, s46, s58
    s_lshl_b32 s59, s59, 5
    s_add_u32 s46, s46, s59
    buffer_load_dwordx4 v[156:159], v3, s[16:19], s53 offen offset:0 nt
    s_waitcnt vmcnt(7)
    v_dot2c_f32_bf16 v15, v120, v16
    v_dot2c_f32_bf16 v15, v121, v17
    v_dot2c_f32_bf16 v15, v122, v18
    v_dot2c_f32_bf16 v15, v123, v19
    v_add_f32_dpp v14, v14, v14 quad_perm:[1,0,3,2] row_mask:0xf bank_mask:0xf
    v_dot2c_f32_bf16 v15, v124, v20
    v_dot2c_f32_bf16 v15, v125, v21
    v_dot2c_f32_bf16 v15, v126, v22
    v_dot2c_f32_bf16 v15, v127, v23
    v_add_f32_dpp v14, v14, v14 quad_perm:[2,3,0,1] row_mask:0xf bank_mask:0xf
    v_dot2c_f32_bf16 v15, v128, v24
    v_dot2c_f32_bf16 v15, v129, v25
    v_dot2c_f32_bf16 v15, v130, v26
    v_dot2c_f32_bf16 v15, v131, v27
    v_add_f32_dpp v14, v14, v14 row_half_mirror row_mask:0xf bank_mask:0xf
    v_readfirstlane_b32 s62, v0
    v_readfirstlane_b32 s60, v1
    s_cmp_lg_u32 s62, 0
    s_cselect_b32 s62, s62, s47
    s_add_u32 s62, s62, s64
    s_mul_i32 s63, s60, 31
    s_ashr_i32 s69, s63, 16
    s_add_u32 s69, s69, s62
    ds_read_b64 v[0:1], v29 offset:712
L_pc31:
    s_memrealtime s[58:59]
    s_waitcnt lgkmcnt(0)
    s_sub_u32 s58, s58, s69
    s_cmp_ge_i32 s58, 1120
    s_cbranch_scc1 L_pd31
    s_sleep 1
    s_branch L_pc31
L_pd31:
    s_getreg_b32 s59, hwreg(7, 0, 4)
    s_add_u32 s46, s46, s58
    s_lshl_b32 s59, s59, 5
    s_add_u32 s46, s46, s59
    buffer_load_dwordx4 v[160:163], v3, s[16:19], s53 offen offset:128 nt
    s_min_u32 s46, s46, 1179647
    v_mov_b32 v34, s46
    s_mov_b64 exec, 1
    ds_add_u32 v29, v34 offset:728
    s_mov_b64 exec, -1
    v_add_f32_dpp v15, v15, v15 quad_perm:[1,0,3,2] row_mask:0xf bank_mask:0xf
    s_nop 1
    v_add_f32_dpp v15, v15, v15 quad_perm:[2,3,0,1] row_mask:0xf bank_mask:0xf
    s_nop 1
    v_add_f32_dpp v15, v15, v15 row_half_mirror row_mask:0xf bank_mask:0xf
    v_cvt_pk_bf16_f32 v16, v8, v9
    v_cvt_pk_bf16_f32 v18, v10, v11
    v_cvt_pk_bf16_f32 v20, v12, v13
    v_cvt_pk_bf16_f32 v22, v14, v15
    v_lshlrev_b32 v8, 16, v16
    v_and_b32 v9, 0xffff0000, v16
    v_lshlrev_b32 v10, 16, v18
    v_and_b32 v11, 0xffff0000, v18
    v_lshlrev_b32 v12, 16, v20
    v_and_b32 v13, 0xffff0000, v20
    v_lshlrev_b32 v14, 16, v22
    v_and_b32 v15, 0xffff0000, v22
    v_mul_f32 v8, 0x3d93cd3a, v8
    v_mul_f32 v9, 0x3d93cd3a, v9
    v_mul_f32 v10, 0x3d93cd3a, v10
    v_mul_f32 v11, 0x3d93cd3a, v11
    v_mul_f32 v12, 0x3d93cd3a, v12
    v_mul_f32 v13, 0x3d93cd3a, v13
    v_mul_f32 v14, 0x3d93cd3a, v14
    v_mul_f32 v15, 0x3d93cd3a, v15
    v_cvt_pk_bf16_f32 v16, v8, v9
    v_cvt_pk_bf16_f32 v18, v10, v11
    v_cvt_pk_bf16_f32 v20, v12, v13
    v_cvt_pk_bf16_f32 v22, v14, v15
    v_lshlrev_b32 v8, 16, v16
    v_and_b32 v9, 0xffff0000, v16
    v_lshlrev_b32 v10, 16, v18
    v_and_b32 v11, 0xffff0000, v18
    v_lshlrev_b32 v12, 16, v20
    v_and_b32 v13, 0xffff0000, v20
    v_lshlrev_b32 v14, 16, v22
    v_and_b32 v15, 0xffff0000, v22
    v_max3_f32 v16, v8, v9, v10
    v_max3_f32 v17, v11, v12, v13
    v_max3_f32 v16, v16, v14, v15
    v_max_f32 v16, v16, v17
    s_nop 1
    v_max_f32_dpp v16, v16, v16 row_ror:8 row_mask:0xf bank_mask:0xf
    s_nop 1
    v_max_f32_dpp v16, v16, v16 row_bcast:15 row_mask:0xa bank_mask:0xf
    s_nop 1
    v_max_f32_dpp v16, v16, v16 row_bcast:31 row_mask:0xc bank_mask:0xf
    v_readfirstlane_b32 s62, v0
    v_readfirstlane_b32 s60, v1
    s_cmp_lg_u32 s62, 0
    s_cselect_b32 s62, s62, s47
    s_add_u32 s62, s62, s64
    s_mul_i32 s63, s60, 32
    s_ashr_i32 s69, s63, 16
    s_add_u32 s69, s69, s62
    ds_read_b64 v[0:1], v29 offset:712
L_pc32:
    s_memrealtime s[58:59]
    s_waitcnt lgkmcnt(0)
    s_sub_u32 s58, s58, s69
    s_cmp_ge_i32 s58, 1150
    s_cbranch_scc1 L_pd32
    s_sleep 1
    s_branch L_pc32
L_pd32:
    buffer_load_dwordx4 v[164:167], v3, s[16:19], s53 offen offset:256 nt
    v_readlane_b32 s61, v16, 63
    s_nop 1
    v_subrev_f32 v8, s61, v8
    v_subrev_f32 v9, s61, v9
    v_subrev_f32 v10, s61, v10
    v_subrev_f32 v11, s61, v11
    v_subrev_f32 v12, s61, v12
    v_subrev_f32 v13, s61, v13
    v_subrev_f32 v14, s61, v14
    v_subrev_f32 v15, s61, v15
    v_mul_f32 v8, 0x3fb8aa3b, v8
    v_mul_f32 v9, 0x3fb8aa3b, v9
    v_mul_f32 v10, 0x3fb8aa3b, v10
    v_mul_f32 v11, 0x3fb8aa3b, v11
    v_mul_f32 v12, 0x3fb8aa3b, v12
    v_mul_f32 v13, 0x3fb8aa3b, v13
    v_mul_f32 v14, 0x3fb8aa3b, v14
    v_mul_f32 v15, 0x3fb8aa3b, v15
    v_exp_f32 v8, v8
    v_exp_f32 v9, v9
    v_exp_f32 v10, v10
    v_exp_f32 v11, v11
    v_exp_f32 v12, v12
    v_exp_f32 v13, v13
    v_exp_f32 v14, v14
    v_exp_f32 v15, v15
    v_add_f32 v17, v8, v9
    v_add_f32 v17, v17, v10
    v_add_f32 v17, v17, v11
    v_add_f32 v17, v17, v12
    v_add_f32 v17, v17, v13
    v_add_f32 v17, v17, v14
    v_add_f32 v17, v17, v15
    v_mov_b32 v18, v35
    s_getreg_b32 s58, hwreg(HW_REG_XCC_ID, 0, 4)
    v_mov_b32 v19, s58
    v_add_f32_dpp v17, v17, v17 row_ror:8 row_mask:0xf bank_mask:0xf
    s_nop 1
    v_add_f32_dpp v17, v17, v17 row_bcast:15 row_mask:0xa bank_mask:0xf
    s_nop 1
    v_add_f32_dpp v17, v17, v17 row_bcast:31 row_mask:0xc bank_mask:0xf
    s_mov_b32 exec_lo, 0
    s_brev_b32 exec_hi, 1
    buffer_store_dwordx4 v[16:19], v29, s[48:51], s56 offen sc1
    ds_write_b32 v32, v33 offset:544
    s_mov_b64 exec, -1
    s_setprio 0
    v_readfirstlane_b32 s62, v0
    v_readfirstlane_b32 s60, v1
    s_cmp_lg_u32 s62, 0
    s_cselect_b32 s62, s62, s47
    s_add_u32 s62, s62, s64
    s_mul_i32 s63, s60, 33
    s_ashr_i32 s69, s63, 16
    s_add_u32 s69, s69, s62
    ds_read_b64 v[0:1], v29 offset:712
L_pc33:
    s_memrealtime s[58:59]
    s_waitcnt lgkmcnt(0)
    s_sub_u32 s58, s58, s69
    s_cmp_ge_i32 s58, 1180
    s_cbranch_scc1 L_pd33
    s_sleep 1
    s_branch L_pc33
L_pd33:
    buffer_load_dwordx4 v[36:39], v3, s[16:19], s53 offen offset:3072 nt
    v_readfirstlane_b32 s62, v0
    v_readfirstlane_b32 s60, v1
    s_cmp_lg_u32 s62, 0
    s_cselect_b32 s62, s62, s47
    s_add_u32 s62, s62, s64
    s_mul_i32 s63, s60, 34
    s_ashr_i32 s69, s63, 16
    s_add_u32 s69, s69, s62
    ds_read_b64 v[0:1], v29 offset:712
L_pc34:
    s_memrealtime s[58:59]
    s_waitcnt lgkmcnt(0)
    s_sub_u32 s58, s58, s69
    s_cmp_ge_i32 s58, 1210
    s_cbranch_scc1 L_pd34
    s_sleep 1
    s_branch L_pc34
L_pd34:
    buffer_load_dwordx4 v[40:43], v3, s[16:19], s53 offen offset:3200 nt
    v_readfirstlane_b32 s62, v0
    v_readfirstlane_b32 s60, v1
    s_cmp_lg_u32 s62, 0
    s_cselect_b32 s62, s62, s47
    s_add_u32 s62, s62, s64
    s_mul_i32 s63, s60, 35
    s_ashr_i32 s69, s63, 16
    s_add_u32 s69, s69, s62
    ds_read_b64 v[0:1], v29 offset:712
L_pc35:
    s_memrealtime s[58:59]
    s_waitcnt lgkmcnt(0)
    s_sub_u32 s58, s58, s69
    s_cmp_ge_i32 s58, 1240
    s_cbranch_scc1 L_pd35
    s_sleep 1
    s_branch L_pc35
L_pd35:
    buffer_load_dwordx4 v[44:47], v3, s[16:19], s53 offen offset:3328 nt
    v_readfirstlane_b32 s62, v0
    v_readfirstlane_b32 s60, v1
    s_cmp_lg_u32 s62, 0
    s_cselect_b32 s62, s62, s47
    s_add_u32 s62, s62, s64
    s_mul_i32 s63, s60, 36
    s_ashr_i32 s69, s63, 16
    s_add_u32 s69, s69, s62
    ds_read_b64 v[0:1], v29 offset:712
L_pc36:
    s_memrealtime s[58:59]
    s_waitcnt lgkmcnt(0)
    s_sub_u32 s58, s58, s69
    s_cmp_ge_i32 s58, 1270
    s_cbranch_scc1 L_pd36
    s_sleep 1
    s_branch L_pc36
L_pd36:
    buffer_load_dwordx4 v[48:51], v3, s[16:19], s54 offen offset:0 nt
    v_readfirstlane_b32 s62, v0
    v_readfirstlane_b32 s60, v1
    s_cmp_lg_u32 s62, 0
    s_cselect_b32 s62, s62, s47
    s_add_u32 s62, s62, s64
    s_mul_i32 s63, s60, 37
    s_ashr_i32 s69, s63, 16
    s_add_u32 s69, s69, s62
    ds_read_b64 v[0:1], v29 offset:712
L_pc37:
    s_memrealtime s[58:59]
    s_waitcnt lgkmcnt(0)
    s_sub_u32 s58, s58, s69
    s_cmp_ge_i32 s58, 1300
    s_cbranch_scc1 L_pd37
    s_sleep 1
    s_branch L_pc37
L_pd37:
    buffer_load_dwordx4 v[52:55], v3, s[16:19], s54 offen offset:128 nt
    v_readfirstlane_b32 s62, v0
    v_readfirstlane_b32 s60, v1
    s_cmp_lg_u32 s62, 0
    s_cselect_b32 s62, s62, s47
    s_add_u32 s62, s62, s64
    s_mul_i32 s63, s60, 38
    s_ashr_i32 s69, s63, 16
    s_add_u32 s69, s69, s62
    ds_read_b64 v[0:1], v29 offset:712
L_pc38:
    s_memrealtime s[58:59]
    s_waitcnt lgkmcnt(0)
    s_sub_u32 s58, s58, s69
    s_cmp_ge_i32 s58, 1330
    s_cbranch_scc1 L_pd38
    s_sleep 1
    s_branch L_pc38
L_pd38:
    buffer_load_dwordx4 v[56:59], v3, s[16:19], s54 offen offset:256 nt
    v_readfirstlane_b32 s62, v0
    v_readfirstlane_b32 s60, v1
    s_cmp_lg_u32 s62, 0
    s_cselect_b32 s62, s62, s47
    s_add_u32 s62, s62, s64
    s_mul_i32 s63, s60, 39
    s_ashr_i32 s69, s63, 16
    s_add_u32 s69, s69, s62
    ds_read_b64 v[0:1], v29 offset:712
L_pc39:
    s_memrealtime s[58:59]
    s_waitcnt lgkmcnt(0)
    s_sub_u32 s58, s58, s69
    s_cmp_ge_i32 s58, 1360
    s_cbranch_scc1 L_pd39
    s_sleep 1
    s_branch L_pc39
L_pd39:
    buffer_load_dwordx4 v[60:63], v3, s[16:19], s54 offen offset:3072 nt
    v_readfirstlane_b32 s62, v0
    v_readfirstlane_b32 s60, v1
    s_cmp_lg_u32 s62, 0
    s_cselect_b32 s62, s62, s47
    s_add_u32 s62, s62, s64
    s_mul_i32 s63, s60, 40
    s_ashr_i32 s69, s63, 16
    s_add_u32 s69, s69, s62
    ds_read_b64 v[0:1], v29 offset:712
L_pc40:
    s_memrealtime s[58:59]
    s_waitcnt lgkmcnt(0)
    s_sub_u32 s58, s58, s69
    s_cmp_ge_i32 s58, 1390
    s_cbranch_scc1 L_pd40
    s_sleep 1
    s_branch L_pc40
L_pd40:
    buffer_load_dwordx4 v[64:67], v3, s[16:19], s54 offen offset:3200 nt
    v_readfirstlane_b32 s62, v0
    v_readfirstlane_b32 s60, v1
    s_cmp_lg_u32 s62, 0
    s_cselect_b32 s62, s62, s47
    s_add_u32 s62, s62, s64
    s_mul_i32 s63, s60, 41
    s_ashr_i32 s69, s63, 16
    s_add_u32 s69, s69, s62
    ds_read_b64 v[0:1], v29 offset:712
L_pc41:
    s_memrealtime s[58:59]
    s_waitcnt lgkmcnt(0)
    s_sub_u32 s58, s58, s69
    s_cmp_ge_i32 s58, 1420
    s_cbranch_scc1 L_pd41
    s_sleep 1
    s_branch L_pc41
L_pd41:
    buffer_load_dwordx4 v[68:71], v3, s[16:19], s54 offen offset:3328 nt
    v_readfirstlane_b32 s62, v0
    v_readfirstlane_b32 s60, v1
    s_cmp_lg_u32 s62, 0
    s_cselect_b32 s62, s62, s47
    s_add_u32 s62, s62, s64
    s_mul_i32 s63, s60, 42
    s_ashr_i32 s69, s63, 16
    s_add_u32 s69, s69, s62
L_pc42:
    s_memrealtime s[58:59]
    s_waitcnt lgkmcnt(0)
    s_sub_u32 s58, s58, s69
    s_cmp_ge_i32 s58, 1450
    s_cbranch_scc1 L_pd42
    s_sleep 1
    s_branch L_pc42
L_pd42:
    buffer_load_dwordx4 v[72:75], v3, s[16:19], s55 offen offset:0 nt
    s_mul_i32 s63, s60, 43
    s_ashr_i32 s69, s63, 16
    s_add_u32 s69, s69, s62
L_pc43:
    s_memrealtime s[58:59]
    s_waitcnt lgkmcnt(0)
    s_sub_u32 s58, s58, s69
    s_cmp_ge_i32 s58, 1480
    s_cbranch_scc1 L_pd43
    s_sleep 1
    s_branch L_pc43
L_pd43:
    buffer_load_dwordx4 v[76:79], v3, s[16:19], s55 offen offset:128 nt
    s_mul_i32 s63, s60, 44
    s_ashr_i32 s69, s63, 16
    s_add_u32 s69, s69, s62
L_pc44:
    s_memrealtime s[58:59]
    s_waitcnt lgkmcnt(0)
    s_sub_u32 s58, s58, s69
    s_cmp_ge_i32 s58, 1510
    s_cbranch_scc1 L_pd44
    s_sleep 1
    s_branch L_pc44
L_pd44:
    buffer_load_dwordx4 v[80:83], v3, s[16:19], s55 offen offset:256 nt
    s_mul_i32 s63, s60, 45
    s_ashr_i32 s69, s63, 16
    s_add_u32 s69, s69, s62
L_pc45:
    s_memrealtime s[58:59]
    s_waitcnt lgkmcnt(0)
    s_sub_u32 s58, s58, s69
    s_cmp_ge_i32 s58, 1540
    s_cbranch_scc1 L_pd45
    s_sleep 1
    s_branch L_pc45
L_pd45:
    buffer_load_dwordx4 v[84:87], v3, s[16:19], s55 offen offset:3072 nt
    s_mul_i32 s63, s60, 46
    s_ashr_i32 s69, s63, 16
    s_add_u32 s69, s69, s62
L_pc46:
    s_memrealtime s[58:59]
    s_waitcnt lgkmcnt(0)
    s_sub_u32 s58, s58, s69
    s_cmp_ge_i32 s58, 1570
    s_cbranch_scc1 L_pd46
    s_sleep 1
    s_branch L_pc46
L_pd46:
    buffer_load_dwordx4 v[88:91], v3, s[16:19], s55 offen offset:3200 nt
    s_mul_i32 s63, s60, 47
    s_ashr_i32 s69, s63, 16
    s_add_u32 s69, s69, s62
L_pc47:
    s_memrealtime s[58:59]
    s_waitcnt lgkmcnt(0)
    s_sub_u32 s58, s58, s69
    s_cmp_ge_i32 s58, 1600
    s_cbranch_scc1 L_pd47
    s_sleep 1
    s_branch L_pc47
L_pd47:
    buffer_load_dwordx4 v[92:95], v3, s[16:19], s55 offen offset:3328 nt
    ds_write_b32 v32, v33 offset:576
    s_mov_b32 s57, 262144
L_ss:
    ds_read_b32 v35, v29 offset:536
    ds_read_b32 v34, v31 offset:1024
    s_sub_u32 s57, s57, 1
    s_cbranch_scc1 L_ss_done
    s_waitcnt lgkmcnt(0)
    v_cmp_eq_u32 vcc, 0, v35
    s_cbranch_vccz L_ss_done
    s_sleep 2
    s_branch L_ss
L_ss_done:
    s_waitcnt lgkmcnt(0)
    v_mul_f32 v8, v8, v34
    v_mul_f32 v9, v9, v34
    v_mul_f32 v10, v10, v34
    v_mul_f32 v11, v11, v34
    v_mul_f32 v12, v12, v34
    v_mul_f32 v13, v13, v34
    v_mul_f32 v14, v14, v34
    v_mul_f32 v15, v15, v34
    v_cvt_pk_bf16_f32 v8, v8, v8
    v_cvt_pk_bf16_f32 v9, v9, v9
    v_cvt_pk_bf16_f32 v10, v10, v10
    v_cvt_pk_bf16_f32 v11, v11, v11
    v_cvt_pk_bf16_f32 v12, v12, v12
    v_cvt_pk_bf16_f32 v13, v13, v13
    v_cvt_pk_bf16_f32 v14, v14, v14
    v_cvt_pk_bf16_f32 v15, v15, v15
    v_and_b32 v128, v8, v4
    v_and_b32 v129, v8, v5
    v_and_b32 v130, v8, v6
    v_and_b32 v131, v8, v7
    s_waitcnt vmcnt(24)
    s_nop 0
    v_mfma_f32_16x16x32_bf16 v[16:19], v[128:131], v[132:135], 0
    s_waitcnt vmcnt(23)
    v_mfma_f32_16x16x32_bf16 v[20:23], v[128:131], v[136:139], 0
    s_waitcnt vmcnt(22)
    v_mfma_f32_16x16x32_bf16 v[24:27], v[128:131], v[140:143], 0
    v_and_b32 v124, v9, v4
    v_and_b32 v125, v9, v5
    v_and_b32 v126, v9, v6
    v_and_b32 v127, v9, v7
    s_waitcnt vmcnt(21)
    s_nop 0
    v_mfma_f32_16x16x32_bf16 v[16:19], v[124:127], v[144:147], v[16:19]
    s_waitcnt vmcnt(20)
    v_mfma_f32_16x16x32_bf16 v[20:23], v[124:127], v[148:151], v[20:23]
    s_waitcnt vmcnt(19)
    v_mfma_f32_16x16x32_bf16 v[24:27], v[124:127], v[152:155], v[24:27]
    v_and_b32 v128, v10, v4
    v_and_b32 v129, v10, v5
    v_and_b32 v130, v10, v6
    v_and_b32 v131, v10, v7
    s_waitcnt vmcnt(18)
    s_nop 0
    v_mfma_f32_16x16x32_bf16 v[16:19], v[128:131], v[156:159], v[16:19]
    s_waitcnt vmcnt(17)
    v_mfma_f32_16x16x32_bf16 v[20:23], v[128:131], v[160:163], v[20:23]
    s_waitcnt vmcnt(16)
    v_mfma_f32_16x16x32_bf16 v[24:27], v[128:131], v[164:167], v[24:27]
    v_and_b32 v124, v11, v4
    v_and_b32 v125, v11, v5
    v_and_b32 v126, v11, v6
    v_and_b32 v127, v11, v7
    s_waitcnt vmcnt(14)
    s_nop 0
    v_mfma_f32_16x16x32_bf16 v[16:19], v[124:127], v[36:39], v[16:19]
    s_waitcnt vmcnt(13)
    v_mfma_f32_16x16x32_bf16 v[20:23], v[124:127], v[40:43], v[20:23]
    s_waitcnt vmcnt(12)
    v_mfma_f32_16x16x32_bf16 v[24:27], v[124:127], v[44:47], v[24:27]
    v_and_b32 v128, v12, v4
    v_and_b32 v129, v12, v5
    v_and_b32 v130, v12, v6
    v_and_b32 v131, v12, v7
    s_waitcnt vmcnt(11)
    s_nop 0
    v_mfma_f32_16x16x32_bf16 v[16:19], v[128:131], v[48:51], v[16:19]
    s_waitcnt vmcnt(10)
    v_mfma_f32_16x16x32_bf16 v[20:23], v[128:131], v[52:55], v[20:23]
    s_waitcnt vmcnt(9)
    v_mfma_f32_16x16x32_bf16 v[24:27], v[128:131], v[56:59], v[24:27]
    v_and_b32 v124, v13, v4
    v_and_b32 v125, v13, v5
    v_and_b32 v126, v13, v6
    v_and_b32 v127, v13, v7
    s_waitcnt vmcnt(8)
    s_nop 0
    v_mfma_f32_16x16x32_bf16 v[16:19], v[124:127], v[60:63], v[16:19]
    s_waitcnt vmcnt(7)
    v_mfma_f32_16x16x32_bf16 v[20:23], v[124:127], v[64:67], v[20:23]
    s_waitcnt vmcnt(6)
    v_mfma_f32_16x16x32_bf16 v[24:27], v[124:127], v[68:71], v[24:27]
    v_and_b32 v128, v14, v4
    v_and_b32 v129, v14, v5
    v_and_b32 v130, v14, v6
    v_and_b32 v131, v14, v7
    s_waitcnt vmcnt(5)
    s_nop 0
    v_mfma_f32_16x16x32_bf16 v[16:19], v[128:131], v[72:75], v[16:19]
    s_waitcnt vmcnt(4)
    v_mfma_f32_16x16x32_bf16 v[20:23], v[128:131], v[76:79], v[20:23]
    s_waitcnt vmcnt(3)
    v_mfma_f32_16x16x32_bf16 v[24:27], v[128:131], v[80:83], v[24:27]
    v_and_b32 v124, v15, v4
    v_and_b32 v125, v15, v5
    v_and_b32 v126, v15, v6
    v_and_b32 v127, v15, v7
    s_waitcnt vmcnt(2)
    s_nop 0
    v_mfma_f32_16x16x32_bf16 v[16:19], v[124:127], v[84:87], v[16:19]
    s_waitcnt vmcnt(1)
    v_mfma_f32_16x16x32_bf16 v[20:23], v[124:127], v[88:91], v[20:23]
    s_waitcnt vmcnt(0)
    v_mfma_f32_16x16x32_bf16 v[24:27], v[124:127], v[92:95], v[24:27]
    s_mov_b32 exec_lo, 0x00ff00ff
    s_mov_b32 exec_hi, 0xff00ff00
    s_nop 1
    ds_write_b128 v30, v[16:19] offset:7680
    s_nop 0
    ds_write_b128 v30, v[20:23] offset:7936
    s_nop 0
    ds_write_b128 v30, v[24:27] offset:8192
    ds_write_b32 v32, v33 offset:672
    s_waitcnt lgkmcnt(0)
L_last:
    s_endpgm
.section .rodata,"a"
.p2align 6
.amdhsa_kernel parallel_sum__mha_block_cached__glu_gated_glu__decode_kernel
  .amdhsa_next_free_vgpr 168
  .amdhsa_next_free_sgpr 70
  .amdhsa_accum_offset 168
  .amdhsa_group_segment_fixed_size 0
  .amdhsa_kernarg_size 96
  .amdhsa_user_sgpr_count 2
  .amdhsa_user_sgpr_kernarg_segment_ptr 1
  .amdhsa_system_sgpr_workgroup_id_x 1
.end_amdhsa_kernel
```
